```python
import torch

def _softmax(x, axis=-1):
    return torch.softmax(x, dim=axis)

def _gelu(x):
    return torch.nn.functional.gelu(x, approximate='tanh')

def _silu(x):
    return torch.nn.functional.silu(x)

def _sigmoid(x):
    return torch.sigmoid(x)

def _layernorm(x, axis=-1, eps=1e-05):
    m = x.mean(dim=axis, keepdim=True)
    v = x.var(dim=axis, keepdim=True, unbiased=False)
    return (x - m) / torch.sqrt(v + eps)

def _scatter_add(tgt, idx, src, axis=0):
    return tgt.clone().index_add_(axis, idx, src)

def _segment_sum(src, seg, n):
    out = torch.zeros((n,) + src.shape[1:], dtype=src.dtype)
    return out.index_add_(0, seg, src)

def _pad(x, pw):
    flat = tuple((v for pair in reversed(pw) for v in pair))
    return torch.nn.functional.pad(x, flat)
kernel_name = 'standalone__transposed_strided__vision'

def setup_inputs():

    _w = lambda a: (lambda t: t.to(torch.bfloat16) if t.is_floating_point() else t)(torch.as_tensor(a))
    H = W = 224
    C = 96
    return {'x': _w((lambda *s: torch.randn(*s, dtype=torch.bfloat16) * 0.05)(1, H, W, C)), 'w': _w((lambda *s: torch.randn(*s, dtype=torch.bfloat16) * 0.05)(4, 4, C, C)), 'b': _w((lambda *s: torch.randn(*s, dtype=torch.bfloat16) * 0.05)(C))}

def reference(x, w, b):
    B, H, W, C = x.shape
    s, k = (2, 4)
    xe = x[:, :, None, :, None, :].clone()
    xz = _pad(xe, ((0, 0), (0, 0), (0, s - 1), (0, 0), (0, s - 1), (0, 0)))
    xz = xz.reshape(B, H * s, W * s, C)[:, :(H - 1) * s + 1, :(W - 1) * s + 1, :]
    xp = _pad(xz, ((0, 0), (k - 1, k - 1), (k - 1, k - 1), (0, 0)))
    Ho, Wo = ((H - 1) * s + k, (W - 1) * s + k)
    out = 0
    for i in range(k):
        for j in range(k):
            out = out + torch.einsum('bhwc,cd->bhwd', xp[:, i:i + Ho, j:j + Wo, :], w[k - 1 - i, k - 1 - j])
    return out[:, 1:-1, 1:-1, :] + b
```

```asm
; @launch grid=(256,1,1) block=(256,1,1) lds=155776
.amdgcn_target "amdgcn-amd-amdhsa--gfx950"
.text
.globl standalone__transposed_strided__vision_kernel
.p2align 8
.type standalone__transposed_strided__vision_kernel,@function
standalone__transposed_strided__vision_kernel:
    s_load_dwordx4 s[4:7], s[0:1], 0
    s_load_dwordx4 s[24:27], s[0:1], 16
    s_and_b32 s3, s2, 7
    s_lshr_b32 s45, s2, 3
    s_and_b32 s31, s45, 1
    s_lshr_b32 s46, s45, 1
    s_lshl_b32 s3, s3, 4
    s_add_u32 s3, s3, s46
    s_cmp_ge_u32 s2, 256
    s_cbranch_scc1 L_end
    s_cmp_ge_u32 s3, 126
    s_cbranch_scc1 L_end
    v_lshrrev_b32 v96, 6, v0
    v_and_b32 v213, 63, v0
    s_mul_i32 s32, s3, 7282
    v_readfirstlane_b32 s28, v96
    s_lshr_b32 s32, s32, 16
    s_mul_i32 s46, s32, 9
    s_sub_u32 s46, s3, s46
    s_mul_i32 s33, s46, 25
    s_and_b32 s29, s28, 1
    s_lshr_b32 s30, s28, 1
    s_cmp_lt_u32 s46, 8
    s_cselect_b32 s34, 12, 11
    s_cmp_eq_u32 s30, 0
    s_cselect_b32 s34, 12, s34
    s_lshl_b32 s52, s45, 2
    s_add_u32 s52, s52, s28
    s_getpc_b64 s[50:51]
L_pc:
    s_lshl_b32 s53, s52, 7
    v_mov_b32 v218, s53
    s_cmp_lt_u32 s53, L_end-L_pc
    s_cbranch_scc0 L_nopf
    global_load_dword v219, v218, s[50:51]
L_nopf:
    s_mul_i32 s47, s52, 2304
    v_lshlrev_b32 v99, 7, v213
    v_add_u32 v99, s47, v99
    v_cmp_gt_u32 vcc, 18, v213
    v_mov_b32 v101, 0x80000000
    v_lshrrev_b32 v96, 4, v213
    v_cndmask_b32 v99, v101, v99, vcc
    v_lshlrev_b32 v212, 4, v96
    s_mul_i32 s46, s30, 1536
    v_lshlrev_b32 v208, 4, v213
    v_lshrrev_b32 v98, 5, v213
    v_add_u32 v208, s46, v208
    v_mul_u32_u24 v98, 1536, v98
    v_add_u32 v210, 1536, v208
    v_add_u32 v209, v208, v98
    s_sub_u32 s46, 1, s31
    s_lshl_b32 s46, s46, 2
    s_sub_u32 s47, 1, s29
    s_add_u32 s46, s46, s47
    s_mul_i32 s36, s46, 18432
    s_mul_i32 s38, s29, 24640
    s_add_u32 s38, s38, 106496
    s_mul_i32 s46, s30, 3080
    s_add_u32 s48, s38, s46
    s_mul_i32 s56, s29, 53248
    s_add_u32 s56, s56, 20480
    s_add_u32 s49, s56, s46
    s_lshl_b32 s46, s28, 6
    s_lshl_b32 s43, s28, 10
    s_lshl_b32 s47, s32, 4
    s_sub_u32 s47, s47, 1
    v_add_u32 v102, s46, v213
    v_mul_u32_u24 v103, 4682, v102
    v_lshrrev_b32 v103, 16, v103
    v_mul_u32_u24 v104, 14, v103
    v_sub_u32 v104, v102, v104
    v_add_u32 v105, s47, v103
    v_cmp_gt_u32 vcc, 12, v104
    v_mul_i32_i24 v106, 192, v105
    v_lshl_add_u32 v106, v104, 4, v106
    v_cndmask_b32 v106, v101, v106, vcc
    v_cmp_gt_u32 vcc, 18, v103
    s_add_u32 s39, s33, s31
    s_sub_u32 s39, s39, 1
    v_cndmask_b32 v106, v101, v106, vcc
    v_cmp_gt_u32 vcc, 224, v105
    s_mul_i32 s44, s39, 43008
    s_mov_b32 s42, 9633792
    v_cndmask_b32 v211, v101, v106, vcc
    s_waitcnt lgkmcnt(0)
    s_mov_b32 s12, s6
    s_mov_b32 s13, s7
    s_mov_b32 s14, 294912
    s_mov_b32 s15, 0x20000
    buffer_load_dword v216, v99, s[12:15], 0 offen
    s_add_u32 m0, s48, 0
    s_add_u32 s37, s36, 0
    buffer_load_dwordx4 v208, s[12:15], s37 offen lds
    buffer_load_dwordx4 v209, s[12:15], s37 offen offset:1024 lds
    buffer_load_dwordx4 v210, s[12:15], s37 offen offset:2048 lds
    s_mov_b32 s20, s24
    s_mov_b32 s21, s25
    s_mov_b32 s22, 192
    s_mov_b32 s23, 0x20000
    buffer_load_dwordx4 v[192:195], v212, s[20:23], 0 offen offset:0
    buffer_load_dwordx4 v[196:199], v212, s[20:23], 0 offen offset:64
    buffer_load_dwordx4 v[200:203], v212, s[20:23], 0 offen offset:128
    s_mov_b32 s8, s4
    s_mov_b32 s9, s5
    s_mov_b32 s10, 9633792
    s_mov_b32 s11, 0x20000
    s_add_u32 m0, s43, 4096
    s_add_u32 s40, s44, 43008
    buffer_load_dwordx4 v211, s[8:11], s40 offen nt lds
    s_add_u32 m0, s43, 57344
    s_add_u32 s40, s44, 602112
    buffer_load_dwordx4 v211, s[8:11], s40 offen nt lds
    s_add_u32 m0, s43, 8192
    s_add_u32 s40, s44, 86016
    buffer_load_dwordx4 v211, s[8:11], s40 offen nt lds
    s_add_u32 m0, s43, 61440
    s_add_u32 s40, s44, 645120
    buffer_load_dwordx4 v211, s[8:11], s40 offen nt lds
    s_add_u32 m0, s43, 12288
    s_add_u32 s40, s44, 129024
    buffer_load_dwordx4 v211, s[8:11], s40 offen nt lds
    s_add_u32 m0, s43, 65536
    s_add_u32 s40, s44, 688128
    buffer_load_dwordx4 v211, s[8:11], s40 offen nt lds
    s_add_u32 m0, s43, 16384
    s_add_u32 s40, s44, 172032
    buffer_load_dwordx4 v211, s[8:11], s40 offen nt lds
    s_add_u32 m0, s43, 69632
    s_add_u32 s40, s44, 731136
    buffer_load_dwordx4 v211, s[8:11], s40 offen nt lds
    s_add_u32 m0, s48, 6160
    s_add_u32 s37, s36, 6144
    buffer_load_dwordx4 v208, s[12:15], s37 offen lds
    buffer_load_dwordx4 v209, s[12:15], s37 offen offset:1024 lds
    buffer_load_dwordx4 v210, s[12:15], s37 offen offset:2048 lds
    s_add_u32 s40, s39, 0
    s_cmp_lt_u32 s40, 224
    s_cselect_b32 s10, s42, 0
    s_add_u32 m0, s43, 0
    s_add_u32 s40, s44, 0
    buffer_load_dwordx4 v211, s[8:11], s40 offen nt lds
    s_mov_b32 s10, s42
    s_add_u32 m0, s43, 53248
    s_add_u32 s40, s44, 559104
    buffer_load_dwordx4 v211, s[8:11], s40 offen nt lds
    s_mov_b32 s16, s26
    s_mov_b32 s17, s27
    s_mov_b32 s18, 38535168
    s_mov_b32 s19, 0x20000
    v_and_b32 v97, 15, v213
    v_add_u32 v98, s29, v97
    v_mul_u32_u24 v98, 224, v98
    v_lshl_add_u32 v98, v96, 4, v98
    s_mul_i32 s46, s30, 53248
    v_add_u32 v204, s46, v98
    v_mul_u32_u24 v98, 384, v97
    v_lshl_add_u32 v98, v96, 4, v98
    s_mul_i32 s46, s29, 192
    v_add_u32 v205, s46, v98
    s_mul_i32 s46, s30, 13
    s_add_u32 s46, s46, s33
    s_lshl_b32 s46, s46, 1
    s_add_u32 s46, s46, s31
    s_mul_i32 s46, s46, 448
    s_lshl_b32 s47, s32, 5
    s_add_u32 s46, s46, s47
    s_mul_i32 s35, s46, 192
    s_mul_i32 s46, s30, 53248
    s_sub_u32 s46, 49152, s46
    v_add_u32 v214, s46, v204
    s_mul_i32 s46, s30, 2236416
    s_sub_u32 s46, 2064384, s46
    s_add_u32 s57, s35, s46
    v_and_b32 v98, 1, v96
    v_mul_u32_u24 v98, 3080, v98
    v_lshrrev_b32 v100, 1, v96
    v_mul_u32_u24 v100, 1536, v100
    v_add_u32 v98, v98, v100
    v_bfe_u32 v100, v213, 2, 2
    v_mul_u32_u24 v100, 192, v100
    v_add_u32 v98, v98, v100
    v_and_b32 v100, 3, v213
    v_lshl_add_u32 v98, v100, 4, v98
    v_add_u32 v206, s38, v98
    v_add_u32 v207, s56, v98
    s_waitcnt vmcnt(13)
    v_lshlrev_b32 v120, 16, v192
    v_and_b32 v121, 0xffff0000, v192
    v_lshlrev_b32 v122, 16, v193
    v_and_b32 v123, 0xffff0000, v193
    v_lshlrev_b32 v124, 16, v194
    v_and_b32 v125, 0xffff0000, v194
    v_lshlrev_b32 v126, 16, v195
    v_and_b32 v127, 0xffff0000, v195
    v_lshlrev_b32 v128, 16, v196
    v_and_b32 v129, 0xffff0000, v196
    v_lshlrev_b32 v130, 16, v197
    v_and_b32 v131, 0xffff0000, v197
    v_lshlrev_b32 v132, 16, v198
    v_and_b32 v133, 0xffff0000, v198
    v_lshlrev_b32 v134, 16, v199
    v_and_b32 v135, 0xffff0000, v199
    v_lshlrev_b32 v136, 16, v200
    v_and_b32 v137, 0xffff0000, v200
    v_lshlrev_b32 v138, 16, v201
    v_and_b32 v139, 0xffff0000, v201
    v_lshlrev_b32 v140, 16, v202
    v_and_b32 v141, 0xffff0000, v202
    v_lshlrev_b32 v142, 16, v203
    v_and_b32 v143, 0xffff0000, v203
    s_waitcnt vmcnt(5)
    s_barrier
    ds_read_b128 v[160:163], v204 offset:4320
    ds_read_b64_tr_b16 a[0:1], v206 offset:0
    ds_read_b64_tr_b16 a[2:3], v206 offset:768
    ds_read_b64_tr_b16 a[4:5], v206 offset:8
    ds_read_b64_tr_b16 a[6:7], v206 offset:776
    ds_read_b64_tr_b16 a[8:9], v206 offset:64
    ds_read_b64_tr_b16 a[10:11], v206 offset:832
    ds_read_b64_tr_b16 a[12:13], v206 offset:72
    ds_read_b64_tr_b16 a[14:15], v206 offset:840
    ds_read_b64_tr_b16 a[16:17], v206 offset:128
    ds_read_b64_tr_b16 a[18:19], v206 offset:896
    ds_read_b64_tr_b16 a[20:21], v206 offset:136
    ds_read_b64_tr_b16 a[22:23], v206 offset:904
    ds_read_b128 v[164:167], v204 offset:8416
    ds_read_b128 v[168:171], v204 offset:12512
    ds_read_b128 v[172:175], v204 offset:16608
    s_add_u32 m0, s48, 12320
    s_add_u32 s37, s36, 12288
    buffer_load_dwordx4 v208, s[12:15], s37 offen lds
    buffer_load_dwordx4 v209, s[12:15], s37 offen offset:1024 lds
    buffer_load_dwordx4 v210, s[12:15], s37 offen offset:2048 lds
    s_waitcnt lgkmcnt(0)
    v_mfma_f32_16x16x32_bf16 v[0:3], a[0:3], v[160:163], v[120:123]
    s_waitcnt vmcnt(5)
    v_mfma_f32_16x16x32_bf16 v[4:7], a[4:7], v[160:163], v[124:127]
    s_barrier
    v_mfma_f32_16x16x32_bf16 v[8:11], a[8:11], v[160:163], v[128:131]
    ds_read_b128 v[144:147], v204 offset:4384
    s_add_u32 m0, s48, 18480
    s_add_u32 s37, s36, 36864
    buffer_load_dwordx4 v208, s[12:15], s37 offen lds
    v_mfma_f32_16x16x32_bf16 v[12:15], a[12:15], v[160:163], v[132:135]
    ds_read_b128 v[148:151], v204 offset:8480
    v_mfma_f32_16x16x32_bf16 v[16:19], a[16:19], v[160:163], v[136:139]
    buffer_load_dwordx4 v209, s[12:15], s37 offen offset:1024 lds
    v_mfma_f32_16x16x32_bf16 v[20:23], a[20:23], v[160:163], v[140:143]
    ds_read_b128 v[152:155], v204 offset:12576
    v_mfma_f32_16x16x32_bf16 v[24:27], a[0:3], v[164:167], v[120:123]
    ds_read_b128 v[156:159], v204 offset:16672
    v_mfma_f32_16x16x32_bf16 v[28:31], a[4:7], v[164:167], v[124:127]
    buffer_load_dwordx4 v210, s[12:15], s37 offen offset:2048 lds
    v_mfma_f32_16x16x32_bf16 v[32:35], a[8:11], v[164:167], v[128:131]
    ds_read_b64_tr_b16 a[24:25], v206 offset:6160
    v_mfma_f32_16x16x32_bf16 v[36:39], a[12:15], v[164:167], v[132:135]
    ds_read_b64_tr_b16 a[26:27], v206 offset:6928
    s_add_u32 m0, s49, 0
    s_add_u32 s37, s36, 43008
    buffer_load_dwordx4 v208, s[12:15], s37 offen lds
    v_mfma_f32_16x16x32_bf16 v[40:43], a[16:19], v[164:167], v[136:139]
    ds_read_b64_tr_b16 a[28:29], v206 offset:6168
    v_mfma_f32_16x16x32_bf16 v[44:47], a[20:23], v[164:167], v[140:143]
    ds_read_b64_tr_b16 a[30:31], v206 offset:6936
    v_mfma_f32_16x16x32_bf16 v[48:51], a[0:3], v[168:171], v[120:123]
    buffer_load_dwordx4 v209, s[12:15], s37 offen offset:1024 lds
    v_mfma_f32_16x16x32_bf16 v[52:55], a[4:7], v[168:171], v[124:127]
    ds_read_b64_tr_b16 a[32:33], v206 offset:6224
    v_mfma_f32_16x16x32_bf16 v[56:59], a[8:11], v[168:171], v[128:131]
    buffer_load_dwordx4 v210, s[12:15], s37 offen offset:2048 lds
    v_mfma_f32_16x16x32_bf16 v[60:63], a[12:15], v[168:171], v[132:135]
    ds_read_b64_tr_b16 a[34:35], v206 offset:6992
    v_mfma_f32_16x16x32_bf16 v[64:67], a[16:19], v[168:171], v[136:139]
    ds_read_b64_tr_b16 a[36:37], v206 offset:6232
    s_add_u32 m0, s49, 6160
    s_add_u32 s37, s36, 49152
    buffer_load_dwordx4 v208, s[12:15], s37 offen lds
    v_mfma_f32_16x16x32_bf16 v[68:71], a[20:23], v[168:171], v[140:143]
    ds_read_b64_tr_b16 a[38:39], v206 offset:7000
    v_mfma_f32_16x16x32_bf16 v[72:75], a[0:3], v[172:175], v[120:123]
    ds_read_b64_tr_b16 a[40:41], v206 offset:6288
    v_mfma_f32_16x16x32_bf16 v[76:79], a[4:7], v[172:175], v[124:127]
    buffer_load_dwordx4 v209, s[12:15], s37 offen offset:1024 lds
    v_mfma_f32_16x16x32_bf16 v[80:83], a[8:11], v[172:175], v[128:131]
    ds_read_b64_tr_b16 a[42:43], v206 offset:7056
    v_mfma_f32_16x16x32_bf16 v[84:87], a[12:15], v[172:175], v[132:135]
    ds_read_b64_tr_b16 a[44:45], v206 offset:6296
    v_mfma_f32_16x16x32_bf16 v[88:91], a[16:19], v[172:175], v[136:139]
    buffer_load_dwordx4 v210, s[12:15], s37 offen offset:2048 lds
    v_mfma_f32_16x16x32_bf16 v[92:95], a[20:23], v[172:175], v[140:143]
    ds_read_b64_tr_b16 a[46:47], v206 offset:7064
    s_waitcnt lgkmcnt(0)
    v_mfma_f32_16x16x32_bf16 v[0:3], a[24:27], v[144:147], v[0:3]
    s_waitcnt vmcnt(6)
    v_mfma_f32_16x16x32_bf16 v[4:7], a[28:31], v[144:147], v[4:7]
    s_barrier
    v_mfma_f32_16x16x32_bf16 v[8:11], a[32:35], v[144:147], v[8:11]
    ds_read_b128 v[160:163], v204 offset:4448
    s_add_u32 m0, s49, 12320
    s_add_u32 s37, s36, 147456
    buffer_load_dwordx4 v208, s[12:15], s37 offen lds
    v_mfma_f32_16x16x32_bf16 v[12:15], a[36:39], v[144:147], v[12:15]
    ds_read_b128 v[164:167], v204 offset:8544
    ds_read_b128 v[168:171], v204 offset:12640
    v_mfma_f32_16x16x32_bf16 v[16:19], a[40:43], v[144:147], v[16:19]
    ds_read_b128 v[172:175], v204 offset:16736
    buffer_load_dwordx4 v209, s[12:15], s37 offen offset:1024 lds
    v_mfma_f32_16x16x32_bf16 v[20:23], a[44:47], v[144:147], v[20:23]
    ds_read_b64_tr_b16 a[48:49], v206 offset:12320
    v_mfma_f32_16x16x32_bf16 v[24:27], a[24:27], v[148:151], v[24:27]
    ds_read_b64_tr_b16 a[50:51], v206 offset:13088
    ds_read_b64_tr_b16 a[52:53], v206 offset:12328
    v_mfma_f32_16x16x32_bf16 v[28:31], a[28:31], v[148:151], v[28:31]
    buffer_load_dwordx4 v210, s[12:15], s37 offen offset:2048 lds
    ds_read_b64_tr_b16 a[54:55], v206 offset:13096
    v_mfma_f32_16x16x32_bf16 v[32:35], a[32:35], v[148:151], v[32:35]
    ds_read_b64_tr_b16 a[56:57], v206 offset:12384
    v_mfma_f32_16x16x32_bf16 v[36:39], a[36:39], v[148:151], v[36:39]
    ds_read_b64_tr_b16 a[58:59], v206 offset:13152
    s_add_u32 m0, s49, 18480
    s_add_u32 s37, s36, 153600
    buffer_load_dwordx4 v208, s[12:15], s37 offen lds
    v_mfma_f32_16x16x32_bf16 v[40:43], a[40:43], v[148:151], v[40:43]
    ds_read_b64_tr_b16 a[60:61], v206 offset:12392
    ds_read_b64_tr_b16 a[62:63], v206 offset:13160
    v_mfma_f32_16x16x32_bf16 v[44:47], a[44:47], v[148:151], v[44:47]
    ds_read_b64_tr_b16 a[64:65], v206 offset:12448
    v_mfma_f32_16x16x32_bf16 v[48:51], a[24:27], v[152:155], v[48:51]
    buffer_load_dwordx4 v209, s[12:15], s37 offen offset:1024 lds
    ds_read_b64_tr_b16 a[66:67], v206 offset:13216
    v_mfma_f32_16x16x32_bf16 v[52:55], a[28:31], v[152:155], v[52:55]
    ds_read_b64_tr_b16 a[68:69], v206 offset:12456
    ds_read_b64_tr_b16 a[70:71], v206 offset:13224
    v_mfma_f32_16x16x32_bf16 v[56:59], a[32:35], v[152:155], v[56:59]
    buffer_load_dwordx4 v210, s[12:15], s37 offen offset:2048 lds
    v_mfma_f32_16x16x32_bf16 v[60:63], a[36:39], v[152:155], v[60:63]
    ds_read_b64_tr_b16 a[72:73], v206 offset:18480
    ds_read_b64_tr_b16 a[74:75], v206 offset:19248
    v_mfma_f32_16x16x32_bf16 v[64:67], a[40:43], v[152:155], v[64:67]
    ds_read_b64_tr_b16 a[76:77], v206 offset:18488
    s_add_u32 m0, s49, 24640
    s_add_u32 s37, s36, 159744
    buffer_load_dwordx4 v208, s[12:15], s37 offen lds
    v_mfma_f32_16x16x32_bf16 v[68:71], a[44:47], v[152:155], v[68:71]
    ds_read_b64_tr_b16 a[78:79], v206 offset:19256
    v_mfma_f32_16x16x32_bf16 v[72:75], a[24:27], v[156:159], v[72:75]
    ds_read_b64_tr_b16 a[80:81], v206 offset:18544
    ds_read_b64_tr_b16 a[82:83], v206 offset:19312
    v_mfma_f32_16x16x32_bf16 v[76:79], a[28:31], v[156:159], v[76:79]
    buffer_load_dwordx4 v209, s[12:15], s37 offen offset:1024 lds
    ds_read_b64_tr_b16 a[84:85], v206 offset:18552
    v_mfma_f32_16x16x32_bf16 v[80:83], a[32:35], v[156:159], v[80:83]
    ds_read_b64_tr_b16 a[86:87], v206 offset:19320
    v_mfma_f32_16x16x32_bf16 v[84:87], a[36:39], v[156:159], v[84:87]
    ds_read_b64_tr_b16 a[88:89], v206 offset:18608
    buffer_load_dwordx4 v210, s[12:15], s37 offen offset:2048 lds
    v_mfma_f32_16x16x32_bf16 v[88:91], a[40:43], v[156:159], v[88:91]
    ds_read_b64_tr_b16 a[90:91], v206 offset:19376
    ds_read_b64_tr_b16 a[92:93], v206 offset:18616
    v_mfma_f32_16x16x32_bf16 v[92:95], a[44:47], v[156:159], v[92:95]
    ds_read_b64_tr_b16 a[94:95], v206 offset:19384
    s_waitcnt lgkmcnt(0)
    v_mfma_f32_16x16x32_bf16 v[0:3], a[48:51], v[160:163], v[0:3]
    s_waitcnt vmcnt(9)
    v_mfma_f32_16x16x32_bf16 v[4:7], a[52:55], v[160:163], v[4:7]
    s_barrier
    v_mfma_f32_16x16x32_bf16 v[8:11], a[56:59], v[160:163], v[8:11]
    ds_read_b128 v[144:147], v204 offset:4096
    s_add_u32 m0, s48, 0
    s_add_u32 s37, s36, 184320
    buffer_load_dwordx4 v208, s[12:15], s37 offen lds
    v_mfma_f32_16x16x32_bf16 v[12:15], a[60:63], v[160:163], v[12:15]
    ds_read_b128 v[148:151], v204 offset:8192
    ds_read_b128 v[152:155], v204 offset:12288
    v_mfma_f32_16x16x32_bf16 v[16:19], a[64:67], v[160:163], v[16:19]
    ds_read_b128 v[156:159], v204 offset:16384
    v_mfma_f32_16x16x32_bf16 v[20:23], a[68:71], v[160:163], v[20:23]
    ds_read_b64_tr_b16 a[96:97], v207 offset:0
    buffer_load_dwordx4 v209, s[12:15], s37 offen offset:1024 lds
    v_mfma_f32_16x16x32_bf16 v[24:27], a[48:51], v[164:167], v[24:27]
    ds_read_b64_tr_b16 a[98:99], v207 offset:768
    v_mfma_f32_16x16x32_bf16 v[28:31], a[52:55], v[164:167], v[28:31]
    ds_read_b64_tr_b16 a[100:101], v207 offset:8
    ds_read_b64_tr_b16 a[102:103], v207 offset:776
    v_mfma_f32_16x16x32_bf16 v[32:35], a[56:59], v[164:167], v[32:35]
    ds_read_b64_tr_b16 a[104:105], v207 offset:64
    v_mfma_f32_16x16x32_bf16 v[36:39], a[60:63], v[164:167], v[36:39]
    ds_read_b64_tr_b16 a[106:107], v207 offset:832
    buffer_load_dwordx4 v210, s[12:15], s37 offen offset:2048 lds
    v_mfma_f32_16x16x32_bf16 v[40:43], a[64:67], v[164:167], v[40:43]
    ds_read_b64_tr_b16 a[108:109], v207 offset:72
    v_mfma_f32_16x16x32_bf16 v[44:47], a[68:71], v[164:167], v[44:47]
    ds_read_b64_tr_b16 a[110:111], v207 offset:840
    ds_read_b64_tr_b16 a[112:113], v207 offset:128
    v_mfma_f32_16x16x32_bf16 v[48:51], a[48:51], v[168:171], v[48:51]
    ds_read_b64_tr_b16 a[114:115], v207 offset:896
    v_mfma_f32_16x16x32_bf16 v[52:55], a[52:55], v[168:171], v[52:55]
    ds_read_b64_tr_b16 a[116:117], v207 offset:136
    s_add_u32 m0, s48, 6160
    s_add_u32 s37, s36, 190464
    buffer_load_dwordx4 v208, s[12:15], s37 offen lds
    v_mfma_f32_16x16x32_bf16 v[56:59], a[56:59], v[168:171], v[56:59]
    ds_read_b64_tr_b16 a[118:119], v207 offset:904
    ds_read_b64_tr_b16 a[120:121], v207 offset:6160
    v_mfma_f32_16x16x32_bf16 v[60:63], a[60:63], v[168:171], v[60:63]
    ds_read_b64_tr_b16 a[122:123], v207 offset:6928
    v_mfma_f32_16x16x32_bf16 v[64:67], a[64:67], v[168:171], v[64:67]
    ds_read_b64_tr_b16 a[124:125], v207 offset:6168
    buffer_load_dwordx4 v209, s[12:15], s37 offen offset:1024 lds
    v_mfma_f32_16x16x32_bf16 v[68:71], a[68:71], v[168:171], v[68:71]
    ds_read_b64_tr_b16 a[126:127], v207 offset:6936
    v_mfma_f32_16x16x32_bf16 v[72:75], a[48:51], v[172:175], v[72:75]
    ds_read_b64_tr_b16 a[128:129], v207 offset:6224
    ds_read_b64_tr_b16 a[130:131], v207 offset:6992
    v_mfma_f32_16x16x32_bf16 v[76:79], a[52:55], v[172:175], v[76:79]
    ds_read_b64_tr_b16 a[132:133], v207 offset:6232
    v_mfma_f32_16x16x32_bf16 v[80:83], a[56:59], v[172:175], v[80:83]
    ds_read_b64_tr_b16 a[134:135], v207 offset:7000
    buffer_load_dwordx4 v210, s[12:15], s37 offen offset:2048 lds
    v_mfma_f32_16x16x32_bf16 v[84:87], a[60:63], v[172:175], v[84:87]
    ds_read_b64_tr_b16 a[136:137], v207 offset:6288
    v_mfma_f32_16x16x32_bf16 v[88:91], a[64:67], v[172:175], v[88:91]
    ds_read_b64_tr_b16 a[138:139], v207 offset:7056
    ds_read_b64_tr_b16 a[140:141], v207 offset:6296
    v_mfma_f32_16x16x32_bf16 v[92:95], a[68:71], v[172:175], v[92:95]
    ds_read_b64_tr_b16 a[142:143], v207 offset:7064
    s_waitcnt lgkmcnt(0)
    v_mfma_f32_16x16x32_bf16 v[0:3], a[72:75], v[144:147], v[0:3]
    s_waitcnt vmcnt(9)
    v_mfma_f32_16x16x32_bf16 v[4:7], a[76:79], v[144:147], v[4:7]
    s_barrier
    v_mfma_f32_16x16x32_bf16 v[8:11], a[80:83], v[144:147], v[8:11]
    ds_read_b128 v[160:163], v204 offset:4160
    s_add_u32 m0, s48, 12320
    s_add_u32 s37, s36, 196608
    buffer_load_dwordx4 v208, s[12:15], s37 offen lds
    v_mfma_f32_16x16x32_bf16 v[12:15], a[84:87], v[144:147], v[12:15]
    ds_read_b128 v[164:167], v204 offset:8256
    ds_read_b128 v[168:171], v204 offset:12352
    v_mfma_f32_16x16x32_bf16 v[16:19], a[88:91], v[144:147], v[16:19]
    ds_read_b128 v[172:175], v204 offset:16448
    buffer_load_dwordx4 v209, s[12:15], s37 offen offset:1024 lds
    v_mfma_f32_16x16x32_bf16 v[20:23], a[92:95], v[144:147], v[20:23]
    ds_read_b64_tr_b16 a[144:145], v207 offset:12320
    v_mfma_f32_16x16x32_bf16 v[24:27], a[72:75], v[148:151], v[24:27]
    ds_read_b64_tr_b16 a[146:147], v207 offset:13088
    ds_read_b64_tr_b16 a[148:149], v207 offset:12328
    v_mfma_f32_16x16x32_bf16 v[28:31], a[76:79], v[148:151], v[28:31]
    buffer_load_dwordx4 v210, s[12:15], s37 offen offset:2048 lds
    ds_read_b64_tr_b16 a[150:151], v207 offset:13096
    v_mfma_f32_16x16x32_bf16 v[32:35], a[80:83], v[148:151], v[32:35]
    ds_read_b64_tr_b16 a[152:153], v207 offset:12384
    v_mfma_f32_16x16x32_bf16 v[36:39], a[84:87], v[148:151], v[36:39]
    ds_read_b64_tr_b16 a[154:155], v207 offset:13152
    s_add_u32 m0, s43, 20480
    s_add_u32 s40, s44, 215040
    buffer_load_dwordx4 v211, s[8:11], s40 offen nt lds
    v_mfma_f32_16x16x32_bf16 v[40:43], a[88:91], v[148:151], v[40:43]
    ds_read_b64_tr_b16 a[156:157], v207 offset:12392
    ds_read_b64_tr_b16 a[158:159], v207 offset:13160
    v_mfma_f32_16x16x32_bf16 v[44:47], a[92:95], v[148:151], v[44:47]
    ds_read_b64_tr_b16 a[160:161], v207 offset:12448
    v_mfma_f32_16x16x32_bf16 v[48:51], a[72:75], v[152:155], v[48:51]
    s_add_u32 m0, s43, 73728
    s_add_u32 s40, s44, 774144
    buffer_load_dwordx4 v211, s[8:11], s40 offen nt lds
    ds_read_b64_tr_b16 a[162:163], v207 offset:13216
    v_mfma_f32_16x16x32_bf16 v[52:55], a[76:79], v[152:155], v[52:55]
    ds_read_b64_tr_b16 a[164:165], v207 offset:12456
    ds_read_b64_tr_b16 a[166:167], v207 offset:13224
    v_mfma_f32_16x16x32_bf16 v[56:59], a[80:83], v[152:155], v[56:59]
    s_add_u32 m0, s43, 24576
    s_add_u32 s40, s44, 258048
    buffer_load_dwordx4 v211, s[8:11], s40 offen nt lds
    v_mfma_f32_16x16x32_bf16 v[60:63], a[84:87], v[152:155], v[60:63]
    ds_read_b64_tr_b16 a[168:169], v207 offset:18480
    ds_read_b64_tr_b16 a[170:171], v207 offset:19248
    v_mfma_f32_16x16x32_bf16 v[64:67], a[88:91], v[152:155], v[64:67]
    ds_read_b64_tr_b16 a[172:173], v207 offset:18488
    s_add_u32 m0, s43, 77824
    s_add_u32 s40, s44, 817152
    buffer_load_dwordx4 v211, s[8:11], s40 offen nt lds
    v_mfma_f32_16x16x32_bf16 v[68:71], a[92:95], v[152:155], v[68:71]
    ds_read_b64_tr_b16 a[174:175], v207 offset:19256
    v_mfma_f32_16x16x32_bf16 v[72:75], a[72:75], v[156:159], v[72:75]
    ds_read_b64_tr_b16 a[176:177], v207 offset:18544
    ds_read_b64_tr_b16 a[178:179], v207 offset:19312
    v_mfma_f32_16x16x32_bf16 v[76:79], a[76:79], v[156:159], v[76:79]
    s_add_u32 m0, s43, 28672
    s_add_u32 s40, s44, 301056
    buffer_load_dwordx4 v211, s[8:11], s40 offen nt lds
    ds_read_b64_tr_b16 a[180:181], v207 offset:18552
    v_mfma_f32_16x16x32_bf16 v[80:83], a[80:83], v[156:159], v[80:83]
    ds_read_b64_tr_b16 a[182:183], v207 offset:19320
    v_mfma_f32_16x16x32_bf16 v[84:87], a[84:87], v[156:159], v[84:87]
    ds_read_b64_tr_b16 a[184:185], v207 offset:18608
    s_add_u32 m0, s43, 81920
    s_add_u32 s40, s44, 860160
    buffer_load_dwordx4 v211, s[8:11], s40 offen nt lds
    v_mfma_f32_16x16x32_bf16 v[88:91], a[88:91], v[156:159], v[88:91]
    ds_read_b64_tr_b16 a[186:187], v207 offset:19376
    ds_read_b64_tr_b16 a[188:189], v207 offset:18616
    v_mfma_f32_16x16x32_bf16 v[92:95], a[92:95], v[156:159], v[92:95]
    ds_read_b64_tr_b16 a[190:191], v207 offset:19384
    s_waitcnt lgkmcnt(0)
    v_mfma_f32_16x16x32_bf16 v[0:3], a[96:99], v[160:163], v[0:3]
    s_waitcnt vmcnt(15)
    v_mfma_f32_16x16x32_bf16 v[4:7], a[100:103], v[160:163], v[4:7]
    s_barrier
    v_mfma_f32_16x16x32_bf16 v[8:11], a[104:107], v[160:163], v[8:11]
    ds_read_b128 v[144:147], v204 offset:4224
    v_mfma_f32_16x16x32_bf16 v[12:15], a[108:111], v[160:163], v[12:15]
    s_add_u32 m0, s43, 32768
    s_add_u32 s40, s44, 344064
    buffer_load_dwordx4 v211, s[8:11], s40 offen nt lds
    v_mfma_f32_16x16x32_bf16 v[16:19], a[112:115], v[160:163], v[16:19]
    ds_read_b128 v[148:151], v204 offset:8320
    v_mfma_f32_16x16x32_bf16 v[20:23], a[116:119], v[160:163], v[20:23]
    ds_read_b128 v[152:155], v204 offset:12416
    v_mfma_f32_16x16x32_bf16 v[24:27], a[96:99], v[164:167], v[24:27]
    s_add_u32 m0, s43, 86016
    s_add_u32 s40, s44, 903168
    buffer_load_dwordx4 v211, s[8:11], s40 offen nt lds
    v_mfma_f32_16x16x32_bf16 v[28:31], a[100:103], v[164:167], v[28:31]
    ds_read_b128 v[156:159], v204 offset:16512
    v_mfma_f32_16x16x32_bf16 v[32:35], a[104:107], v[164:167], v[32:35]
    ds_read_b64_tr_b16 a[192:193], v207 offset:24640
    v_mfma_f32_16x16x32_bf16 v[36:39], a[108:111], v[164:167], v[36:39]
    ds_read_b64_tr_b16 a[194:195], v207 offset:25408
    v_mfma_f32_16x16x32_bf16 v[40:43], a[112:115], v[164:167], v[40:43]
    s_add_u32 m0, s43, 36864
    s_add_u32 s40, s44, 387072
    buffer_load_dwordx4 v211, s[8:11], s40 offen nt lds
    v_mfma_f32_16x16x32_bf16 v[44:47], a[116:119], v[164:167], v[44:47]
    ds_read_b64_tr_b16 a[196:197], v207 offset:24648
    v_mfma_f32_16x16x32_bf16 v[48:51], a[96:99], v[168:171], v[48:51]
    ds_read_b64_tr_b16 a[198:199], v207 offset:25416
    v_mfma_f32_16x16x32_bf16 v[52:55], a[100:103], v[168:171], v[52:55]
    ds_read_b64_tr_b16 a[200:201], v207 offset:24704
    v_mfma_f32_16x16x32_bf16 v[56:59], a[104:107], v[168:171], v[56:59]
    s_add_u32 m0, s43, 90112
    s_add_u32 s40, s44, 946176
    buffer_load_dwordx4 v211, s[8:11], s40 offen nt lds
    v_mfma_f32_16x16x32_bf16 v[60:63], a[108:111], v[168:171], v[60:63]
    ds_read_b64_tr_b16 a[202:203], v207 offset:25472
    v_mfma_f32_16x16x32_bf16 v[64:67], a[112:115], v[168:171], v[64:67]
    ds_read_b64_tr_b16 a[204:205], v207 offset:24712
    v_mfma_f32_16x16x32_bf16 v[68:71], a[116:119], v[168:171], v[68:71]
    s_add_u32 m0, s43, 40960
    s_add_u32 s40, s44, 430080
    buffer_load_dwordx4 v211, s[8:11], s40 offen nt lds
    v_mfma_f32_16x16x32_bf16 v[72:75], a[96:99], v[172:175], v[72:75]
    ds_read_b64_tr_b16 a[206:207], v207 offset:25480
    v_mfma_f32_16x16x32_bf16 v[76:79], a[100:103], v[172:175], v[76:79]
    ds_read_b64_tr_b16 a[208:209], v207 offset:24768
    v_mfma_f32_16x16x32_bf16 v[80:83], a[104:107], v[172:175], v[80:83]
    ds_read_b64_tr_b16 a[210:211], v207 offset:25536
    v_mfma_f32_16x16x32_bf16 v[84:87], a[108:111], v[172:175], v[84:87]
    s_add_u32 m0, s43, 94208
    s_add_u32 s40, s44, 989184
    buffer_load_dwordx4 v211, s[8:11], s40 offen nt lds
    v_mfma_f32_16x16x32_bf16 v[88:91], a[112:115], v[172:175], v[88:91]
    ds_read_b64_tr_b16 a[212:213], v207 offset:24776
    v_mfma_f32_16x16x32_bf16 v[92:95], a[116:119], v[172:175], v[92:95]
    ds_read_b64_tr_b16 a[214:215], v207 offset:25544
    s_waitcnt lgkmcnt(0)
    v_mfma_f32_16x16x32_bf16 v[0:3], a[120:123], v[144:147], v[0:3]
    s_waitcnt vmcnt(12)
    v_mfma_f32_16x16x32_bf16 v[4:7], a[124:127], v[144:147], v[4:7]
    s_barrier
    v_mfma_f32_16x16x32_bf16 v[8:11], a[128:131], v[144:147], v[8:11]
    ds_read_b128 v[160:163], v204 offset:224
    v_mfma_f32_16x16x32_bf16 v[12:15], a[132:135], v[144:147], v[12:15]
    s_add_u32 m0, s43, 45056
    s_add_u32 s40, s44, 473088
    buffer_load_dwordx4 v211, s[8:11], s40 offen nt lds
    v_mfma_f32_16x16x32_bf16 v[16:19], a[136:139], v[144:147], v[16:19]
    ds_read_b128 v[164:167], v204 offset:4320
    v_mfma_f32_16x16x32_bf16 v[20:23], a[140:143], v[144:147], v[20:23]
    ds_read_b128 v[168:171], v204 offset:8416
    v_mfma_f32_16x16x32_bf16 v[24:27], a[120:123], v[148:151], v[24:27]
    ds_read_b128 v[172:175], v204 offset:12512
    v_mfma_f32_16x16x32_bf16 v[28:31], a[124:127], v[148:151], v[28:31]
    ds_read_b64_tr_b16 a[216:217], v206 offset:0
    v_mfma_f32_16x16x32_bf16 v[32:35], a[128:131], v[148:151], v[32:35]
    s_add_u32 s40, s39, 24
    s_cmp_lt_u32 s40, 224
    s_cselect_b32 s10, s42, 0
    s_add_u32 m0, s43, 98304
    s_add_u32 s40, s44, 1032192
    buffer_load_dwordx4 v211, s[8:11], s40 offen nt lds
    v_mfma_f32_16x16x32_bf16 v[36:39], a[132:135], v[148:151], v[36:39]
    ds_read_b64_tr_b16 a[218:219], v206 offset:768
    v_mfma_f32_16x16x32_bf16 v[40:43], a[136:139], v[148:151], v[40:43]
    ds_read_b64_tr_b16 a[220:221], v206 offset:8
    v_mfma_f32_16x16x32_bf16 v[44:47], a[140:143], v[148:151], v[44:47]
    ds_read_b64_tr_b16 a[222:223], v206 offset:776
    v_mfma_f32_16x16x32_bf16 v[48:51], a[120:123], v[152:155], v[48:51]
    v_mfma_f32_16x16x32_bf16 v[52:55], a[124:127], v[152:155], v[52:55]
    ds_read_b64_tr_b16 a[224:225], v206 offset:64
    v_mfma_f32_16x16x32_bf16 v[56:59], a[128:131], v[152:155], v[56:59]
    s_mov_b32 s10, s42
    s_add_u32 m0, s43, 49152
    s_add_u32 s40, s44, 516096
    buffer_load_dwordx4 v211, s[8:11], s40 offen nt lds
    v_mfma_f32_16x16x32_bf16 v[60:63], a[132:135], v[152:155], v[60:63]
    ds_read_b64_tr_b16 a[226:227], v206 offset:832
    v_mfma_f32_16x16x32_bf16 v[64:67], a[136:139], v[152:155], v[64:67]
    ds_read_b64_tr_b16 a[228:229], v206 offset:72
    v_mfma_f32_16x16x32_bf16 v[68:71], a[140:143], v[152:155], v[68:71]
    ds_read_b64_tr_b16 a[230:231], v206 offset:840
    v_mfma_f32_16x16x32_bf16 v[72:75], a[120:123], v[156:159], v[72:75]
    ds_read_b64_tr_b16 a[232:233], v206 offset:128
    v_mfma_f32_16x16x32_bf16 v[76:79], a[124:127], v[156:159], v[76:79]
    s_add_u32 s40, s39, 25
    s_cmp_lt_u32 s40, 224
    s_cselect_b32 s10, s42, 0
    s_add_u32 m0, s43, 102400
    s_add_u32 s40, s44, 1075200
    buffer_load_dwordx4 v211, s[8:11], s40 offen nt lds
    s_mov_b32 s10, s42
    v_mfma_f32_16x16x32_bf16 v[80:83], a[128:131], v[156:159], v[80:83]
    ds_read_b64_tr_b16 a[234:235], v206 offset:896
    v_mfma_f32_16x16x32_bf16 v[84:87], a[132:135], v[156:159], v[84:87]
    ds_read_b64_tr_b16 a[236:237], v206 offset:136
    v_mfma_f32_16x16x32_bf16 v[88:91], a[136:139], v[156:159], v[88:91]
    ds_read_b64_tr_b16 a[238:239], v206 offset:904
    v_mfma_f32_16x16x32_bf16 v[92:95], a[140:143], v[156:159], v[92:95]
    s_waitcnt lgkmcnt(0)
    v_mfma_f32_16x16x32_bf16 v[0:3], a[144:147], v[160:163], v[0:3]
    ds_read_b128 v[144:147], v204 offset:288
    v_mfma_f32_16x16x32_bf16 v[4:7], a[148:151], v[160:163], v[4:7]
    ds_read_b128 v[148:151], v204 offset:4384
    v_mfma_f32_16x16x32_bf16 v[8:11], a[152:155], v[160:163], v[8:11]
    ds_read_b128 v[152:155], v204 offset:8480
    v_mfma_f32_16x16x32_bf16 v[12:15], a[156:159], v[160:163], v[12:15]
    ds_read_b128 v[156:159], v204 offset:12576
    v_mfma_f32_16x16x32_bf16 v[16:19], a[160:163], v[160:163], v[16:19]
    v_mfma_f32_16x16x32_bf16 v[20:23], a[164:167], v[160:163], v[20:23]
    ds_read_b64_tr_b16 a[240:241], v206 offset:6160
    v_mfma_f32_16x16x32_bf16 v[24:27], a[144:147], v[164:167], v[24:27]
    ds_read_b64_tr_b16 a[242:243], v206 offset:6928
    v_mfma_f32_16x16x32_bf16 v[28:31], a[148:151], v[164:167], v[28:31]
    ds_read_b64_tr_b16 a[244:245], v206 offset:6168
    v_mfma_f32_16x16x32_bf16 v[32:35], a[152:155], v[164:167], v[32:35]
    ds_read_b64_tr_b16 a[246:247], v206 offset:6936
    v_mfma_f32_16x16x32_bf16 v[36:39], a[156:159], v[164:167], v[36:39]
    v_mfma_f32_16x16x32_bf16 v[40:43], a[160:163], v[164:167], v[40:43]
    ds_read_b64_tr_b16 a[248:249], v206 offset:6224
    v_mfma_f32_16x16x32_bf16 v[44:47], a[164:167], v[164:167], v[44:47]
    ds_read_b64_tr_b16 a[250:251], v206 offset:6992
    v_mfma_f32_16x16x32_bf16 v[48:51], a[144:147], v[168:171], v[48:51]
    ds_read_b64_tr_b16 a[252:253], v206 offset:6232
    v_mfma_f32_16x16x32_bf16 v[52:55], a[148:151], v[168:171], v[52:55]
    ds_read_b64_tr_b16 a[254:255], v206 offset:7000
    v_mfma_f32_16x16x32_bf16 v[56:59], a[152:155], v[168:171], v[56:59]
    v_mfma_f32_16x16x32_bf16 v[60:63], a[156:159], v[168:171], v[60:63]
    ds_read_b64_tr_b16 v[224:225], v206 offset:6288
    v_mfma_f32_16x16x32_bf16 v[64:67], a[160:163], v[168:171], v[64:67]
    ds_read_b64_tr_b16 v[226:227], v206 offset:7056
    v_mfma_f32_16x16x32_bf16 v[68:71], a[164:167], v[168:171], v[68:71]
    ds_read_b64_tr_b16 v[228:229], v206 offset:6296
    v_mfma_f32_16x16x32_bf16 v[72:75], a[144:147], v[172:175], v[72:75]
    ds_read_b64_tr_b16 v[230:231], v206 offset:7064
    v_mfma_f32_16x16x32_bf16 v[76:79], a[148:151], v[172:175], v[76:79]
    v_mfma_f32_16x16x32_bf16 v[80:83], a[152:155], v[172:175], v[80:83]
    v_mfma_f32_16x16x32_bf16 v[84:87], a[156:159], v[172:175], v[84:87]
    v_mfma_f32_16x16x32_bf16 v[88:91], a[160:163], v[172:175], v[88:91]
    v_mfma_f32_16x16x32_bf16 v[92:95], a[164:167], v[172:175], v[92:95]
    s_waitcnt lgkmcnt(0)
    v_mfma_f32_16x16x32_bf16 v[0:3], a[168:171], v[144:147], v[0:3]
    ds_read_b128 v[160:163], v204 offset:352
    v_mfma_f32_16x16x32_bf16 v[4:7], a[172:175], v[144:147], v[4:7]
    ds_read_b128 v[164:167], v204 offset:4448
    v_mfma_f32_16x16x32_bf16 v[8:11], a[176:179], v[144:147], v[8:11]
    ds_read_b128 v[168:171], v204 offset:8544
    v_mfma_f32_16x16x32_bf16 v[12:15], a[180:183], v[144:147], v[12:15]
    ds_read_b128 v[172:175], v204 offset:12640
    v_mfma_f32_16x16x32_bf16 v[16:19], a[184:187], v[144:147], v[16:19]
    v_mfma_f32_16x16x32_bf16 v[20:23], a[188:191], v[144:147], v[20:23]
    ds_read_b64_tr_b16 v[232:233], v206 offset:12320
    v_mfma_f32_16x16x32_bf16 v[24:27], a[168:171], v[148:151], v[24:27]
    ds_read_b64_tr_b16 v[234:235], v206 offset:13088
    v_mfma_f32_16x16x32_bf16 v[28:31], a[172:175], v[148:151], v[28:31]
    ds_read_b64_tr_b16 v[236:237], v206 offset:12328
    v_mfma_f32_16x16x32_bf16 v[32:35], a[176:179], v[148:151], v[32:35]
    ds_read_b64_tr_b16 v[238:239], v206 offset:13096
    v_mfma_f32_16x16x32_bf16 v[36:39], a[180:183], v[148:151], v[36:39]
    v_mfma_f32_16x16x32_bf16 v[40:43], a[184:187], v[148:151], v[40:43]
    ds_read_b64_tr_b16 v[240:241], v206 offset:12384
    v_mfma_f32_16x16x32_bf16 v[44:47], a[188:191], v[148:151], v[44:47]
    ds_read_b64_tr_b16 v[242:243], v206 offset:13152
    v_mfma_f32_16x16x32_bf16 v[48:51], a[168:171], v[152:155], v[48:51]
    ds_read_b64_tr_b16 v[244:245], v206 offset:12392
    v_mfma_f32_16x16x32_bf16 v[52:55], a[172:175], v[152:155], v[52:55]
    ds_read_b64_tr_b16 v[246:247], v206 offset:13160
    v_mfma_f32_16x16x32_bf16 v[56:59], a[176:179], v[152:155], v[56:59]
    v_mfma_f32_16x16x32_bf16 v[60:63], a[180:183], v[152:155], v[60:63]
    ds_read_b64_tr_b16 v[248:249], v206 offset:12448
    v_mfma_f32_16x16x32_bf16 v[64:67], a[184:187], v[152:155], v[64:67]
    ds_read_b64_tr_b16 v[250:251], v206 offset:13216
    v_mfma_f32_16x16x32_bf16 v[68:71], a[188:191], v[152:155], v[68:71]
    ds_read_b64_tr_b16 v[252:253], v206 offset:12456
    v_mfma_f32_16x16x32_bf16 v[72:75], a[168:171], v[156:159], v[72:75]
    ds_read_b64_tr_b16 v[254:255], v206 offset:13224
    v_mfma_f32_16x16x32_bf16 v[76:79], a[172:175], v[156:159], v[76:79]
    v_mfma_f32_16x16x32_bf16 v[80:83], a[176:179], v[156:159], v[80:83]
    v_mfma_f32_16x16x32_bf16 v[84:87], a[180:183], v[156:159], v[84:87]
    v_mfma_f32_16x16x32_bf16 v[88:91], a[184:187], v[156:159], v[88:91]
    v_mfma_f32_16x16x32_bf16 v[92:95], a[188:191], v[156:159], v[92:95]
    s_waitcnt lgkmcnt(0)
    v_mfma_f32_16x16x32_bf16 v[0:3], a[192:195], v[160:163], v[0:3]
    ds_read_b128 v[144:147], v204 offset:0
    v_mfma_f32_16x16x32_bf16 v[4:7], a[196:199], v[160:163], v[4:7]
    ds_read_b128 v[148:151], v204 offset:4096
    v_mfma_f32_16x16x32_bf16 v[8:11], a[200:203], v[160:163], v[8:11]
    v_mfma_f32_16x16x32_bf16 v[12:15], a[204:207], v[160:163], v[12:15]
    ds_read_b128 v[152:155], v204 offset:8192
    v_mfma_f32_16x16x32_bf16 v[16:19], a[208:211], v[160:163], v[16:19]
    ds_read_b128 v[156:159], v204 offset:12288
    v_mfma_f32_16x16x32_bf16 v[20:23], a[212:215], v[160:163], v[20:23]
    v_mfma_f32_16x16x32_bf16 v[24:27], a[192:195], v[164:167], v[24:27]
    v_mfma_f32_16x16x32_bf16 v[28:31], a[196:199], v[164:167], v[28:31]
    v_mfma_f32_16x16x32_bf16 v[32:35], a[200:203], v[164:167], v[32:35]
    v_mfma_f32_16x16x32_bf16 v[36:39], a[204:207], v[164:167], v[36:39]
    v_mfma_f32_16x16x32_bf16 v[40:43], a[208:211], v[164:167], v[40:43]
    v_mfma_f32_16x16x32_bf16 v[44:47], a[212:215], v[164:167], v[44:47]
    v_mfma_f32_16x16x32_bf16 v[48:51], a[192:195], v[168:171], v[48:51]
    v_mfma_f32_16x16x32_bf16 v[52:55], a[196:199], v[168:171], v[52:55]
    v_mfma_f32_16x16x32_bf16 v[56:59], a[200:203], v[168:171], v[56:59]
    v_mfma_f32_16x16x32_bf16 v[60:63], a[204:207], v[168:171], v[60:63]
    v_mfma_f32_16x16x32_bf16 v[64:67], a[208:211], v[168:171], v[64:67]
    v_mfma_f32_16x16x32_bf16 v[68:71], a[212:215], v[168:171], v[68:71]
    v_mfma_f32_16x16x32_bf16 v[72:75], a[192:195], v[172:175], v[72:75]
    v_mfma_f32_16x16x32_bf16 v[76:79], a[196:199], v[172:175], v[76:79]
    v_mfma_f32_16x16x32_bf16 v[80:83], a[200:203], v[172:175], v[80:83]
    v_mfma_f32_16x16x32_bf16 v[84:87], a[204:207], v[172:175], v[84:87]
    v_mfma_f32_16x16x32_bf16 v[88:91], a[208:211], v[172:175], v[88:91]
    v_mfma_f32_16x16x32_bf16 v[92:95], a[212:215], v[172:175], v[92:95]
    s_waitcnt lgkmcnt(0)
    v_mfma_f32_16x16x32_bf16 v[0:3], a[216:219], v[144:147], v[0:3]
    ds_read_b128 v[160:163], v204 offset:64
    v_mfma_f32_16x16x32_bf16 v[4:7], a[220:223], v[144:147], v[4:7]
    ds_read_b128 v[164:167], v204 offset:4160
    v_mfma_f32_16x16x32_bf16 v[8:11], a[224:227], v[144:147], v[8:11]
    v_mfma_f32_16x16x32_bf16 v[12:15], a[228:231], v[144:147], v[12:15]
    ds_read_b128 v[168:171], v204 offset:8256
    v_mfma_f32_16x16x32_bf16 v[16:19], a[232:235], v[144:147], v[16:19]
    ds_read_b128 v[172:175], v204 offset:12352
    v_mfma_f32_16x16x32_bf16 v[20:23], a[236:239], v[144:147], v[20:23]
    v_mfma_f32_16x16x32_bf16 v[24:27], a[216:219], v[148:151], v[24:27]
    v_mfma_f32_16x16x32_bf16 v[28:31], a[220:223], v[148:151], v[28:31]
    v_mfma_f32_16x16x32_bf16 v[32:35], a[224:227], v[148:151], v[32:35]
    v_mfma_f32_16x16x32_bf16 v[36:39], a[228:231], v[148:151], v[36:39]
    v_mfma_f32_16x16x32_bf16 v[40:43], a[232:235], v[148:151], v[40:43]
    v_mfma_f32_16x16x32_bf16 v[44:47], a[236:239], v[148:151], v[44:47]
    v_mfma_f32_16x16x32_bf16 v[48:51], a[216:219], v[152:155], v[48:51]
    v_mfma_f32_16x16x32_bf16 v[52:55], a[220:223], v[152:155], v[52:55]
    v_mfma_f32_16x16x32_bf16 v[56:59], a[224:227], v[152:155], v[56:59]
    v_mfma_f32_16x16x32_bf16 v[60:63], a[228:231], v[152:155], v[60:63]
    v_mfma_f32_16x16x32_bf16 v[64:67], a[232:235], v[152:155], v[64:67]
    v_mfma_f32_16x16x32_bf16 v[68:71], a[236:239], v[152:155], v[68:71]
    v_mfma_f32_16x16x32_bf16 v[72:75], a[216:219], v[156:159], v[72:75]
    v_mfma_f32_16x16x32_bf16 v[76:79], a[220:223], v[156:159], v[76:79]
    v_mfma_f32_16x16x32_bf16 v[80:83], a[224:227], v[156:159], v[80:83]
    v_mfma_f32_16x16x32_bf16 v[84:87], a[228:231], v[156:159], v[84:87]
    v_mfma_f32_16x16x32_bf16 v[88:91], a[232:235], v[156:159], v[88:91]
    v_mfma_f32_16x16x32_bf16 v[92:95], a[236:239], v[156:159], v[92:95]
    s_waitcnt lgkmcnt(0)
    v_mfma_f32_16x16x32_bf16 v[0:3], a[240:243], v[160:163], v[0:3]
    ds_read_b128 v[144:147], v204 offset:128
    v_mfma_f32_16x16x32_bf16 v[4:7], a[244:247], v[160:163], v[4:7]
    ds_read_b128 v[148:151], v204 offset:4224
    v_mfma_f32_16x16x32_bf16 v[8:11], a[248:251], v[160:163], v[8:11]
    v_mfma_f32_16x16x32_bf16 v[12:15], a[252:255], v[160:163], v[12:15]
    ds_read_b128 v[152:155], v204 offset:8320
    v_mfma_f32_16x16x32_bf16 v[16:19], v[224:227], v[160:163], v[16:19]
    ds_read_b128 v[156:159], v204 offset:12416
    v_mfma_f32_16x16x32_bf16 v[20:23], v[228:231], v[160:163], v[20:23]
    v_mfma_f32_16x16x32_bf16 v[24:27], a[240:243], v[164:167], v[24:27]
    v_mfma_f32_16x16x32_bf16 v[28:31], a[244:247], v[164:167], v[28:31]
    v_mfma_f32_16x16x32_bf16 v[32:35], a[248:251], v[164:167], v[32:35]
    v_mfma_f32_16x16x32_bf16 v[36:39], a[252:255], v[164:167], v[36:39]
    v_mfma_f32_16x16x32_bf16 v[40:43], v[224:227], v[164:167], v[40:43]
    v_mfma_f32_16x16x32_bf16 v[44:47], v[228:231], v[164:167], v[44:47]
    v_mfma_f32_16x16x32_bf16 v[48:51], a[240:243], v[168:171], v[48:51]
    v_mfma_f32_16x16x32_bf16 v[52:55], a[244:247], v[168:171], v[52:55]
    v_mfma_f32_16x16x32_bf16 v[56:59], a[248:251], v[168:171], v[56:59]
    v_mfma_f32_16x16x32_bf16 v[60:63], a[252:255], v[168:171], v[60:63]
    v_mfma_f32_16x16x32_bf16 v[64:67], v[224:227], v[168:171], v[64:67]
    v_mfma_f32_16x16x32_bf16 v[68:71], v[228:231], v[168:171], v[68:71]
    v_mfma_f32_16x16x32_bf16 v[72:75], a[240:243], v[172:175], v[72:75]
    v_mfma_f32_16x16x32_bf16 v[76:79], a[244:247], v[172:175], v[76:79]
    v_mfma_f32_16x16x32_bf16 v[80:83], a[248:251], v[172:175], v[80:83]
    v_mfma_f32_16x16x32_bf16 v[84:87], a[252:255], v[172:175], v[84:87]
    v_mfma_f32_16x16x32_bf16 v[88:91], v[224:227], v[172:175], v[88:91]
    v_mfma_f32_16x16x32_bf16 v[92:95], v[228:231], v[172:175], v[92:95]
    s_waitcnt lgkmcnt(0)
    v_mfma_f32_16x16x32_bf16 v[0:3], v[232:235], v[144:147], v[0:3]
    ds_read_b128 v[168:171], v204 offset:16608
    v_mfma_f32_16x16x32_bf16 v[4:7], v[236:239], v[144:147], v[4:7]
    ds_read_b128 v[172:175], v204 offset:16672
    v_mfma_f32_16x16x32_bf16 v[8:11], v[240:243], v[144:147], v[8:11]
    v_mfma_f32_16x16x32_bf16 v[12:15], v[244:247], v[144:147], v[12:15]
    ds_read_b128 v[176:179], v204 offset:16736
    v_mfma_f32_16x16x32_bf16 v[16:19], v[248:251], v[144:147], v[16:19]
    ds_read_b128 v[180:183], v204 offset:16384
    v_mfma_f32_16x16x32_bf16 v[20:23], v[252:255], v[144:147], v[20:23]
    v_mfma_f32_16x16x32_bf16 v[24:27], v[232:235], v[148:151], v[24:27]
    ds_read_b128 v[184:187], v204 offset:16448
    v_mfma_f32_16x16x32_bf16 v[28:31], v[236:239], v[148:151], v[28:31]
    ds_read_b128 v[188:191], v204 offset:16512
    v_mfma_f32_16x16x32_bf16 v[32:35], v[240:243], v[148:151], v[32:35]
    v_mfma_f32_16x16x32_bf16 v[36:39], v[244:247], v[148:151], v[36:39]
    v_cvt_pk_bf16_f32 v192, v0, v1
    v_cvt_pk_bf16_f32 v193, v2, v3
    v_mfma_f32_16x16x32_bf16 v[40:43], v[248:251], v[148:151], v[40:43]
    v_mfma_f32_16x16x32_bf16 v[44:47], v[252:255], v[148:151], v[44:47]
    v_cvt_pk_bf16_f32 v194, v4, v5
    v_cvt_pk_bf16_f32 v195, v6, v7
    v_mfma_f32_16x16x32_bf16 v[48:51], v[232:235], v[152:155], v[48:51]
    v_mfma_f32_16x16x32_bf16 v[52:55], v[236:239], v[152:155], v[52:55]
    v_mfma_f32_16x16x32_bf16 v[56:59], v[240:243], v[152:155], v[56:59]
    v_cvt_pk_bf16_f32 v196, v8, v9
    v_cvt_pk_bf16_f32 v197, v10, v11
    v_mfma_f32_16x16x32_bf16 v[60:63], v[244:247], v[152:155], v[60:63]
    v_mfma_f32_16x16x32_bf16 v[64:67], v[248:251], v[152:155], v[64:67]
    v_cvt_pk_bf16_f32 v198, v12, v13
    v_cvt_pk_bf16_f32 v199, v14, v15
    v_mfma_f32_16x16x32_bf16 v[68:71], v[252:255], v[152:155], v[68:71]
    v_mfma_f32_16x16x32_bf16 v[72:75], v[232:235], v[156:159], v[72:75]
    v_mfma_f32_16x16x32_bf16 v[76:79], v[236:239], v[156:159], v[76:79]
    v_cvt_pk_bf16_f32 v200, v16, v17
    v_cvt_pk_bf16_f32 v201, v18, v19
    v_mfma_f32_16x16x32_bf16 v[80:83], v[240:243], v[156:159], v[80:83]
    v_mfma_f32_16x16x32_bf16 v[84:87], v[244:247], v[156:159], v[84:87]
    v_cvt_pk_bf16_f32 v202, v20, v21
    v_cvt_pk_bf16_f32 v203, v22, v23
    v_mfma_f32_16x16x32_bf16 v[88:91], v[248:251], v[156:159], v[88:91]
    v_mfma_f32_16x16x32_bf16 v[92:95], v[252:255], v[156:159], v[92:95]
    s_waitcnt vmcnt(0)
    s_barrier
L_main:
    s_waitcnt lgkmcnt(0)
    v_mfma_f32_16x16x32_bf16 v[0:3], a[144:147], v[168:171], v[120:123]
    ds_read_b128 v[144:147], v204 offset:20704
    v_mfma_f32_16x16x32_bf16 v[0:3], a[168:171], v[172:175], v[0:3]
    ds_read_b128 v[148:151], v204 offset:20768
    v_mfma_f32_16x16x32_bf16 v[0:3], a[192:195], v[176:179], v[0:3]
    ds_read_b128 v[152:155], v204 offset:20832
    v_mfma_f32_16x16x32_bf16 v[0:3], a[216:219], v[180:183], v[0:3]
    ds_read_b128 v[156:159], v204 offset:20480
    v_mfma_f32_16x16x32_bf16 v[0:3], a[240:243], v[184:187], v[0:3]
    ds_read_b128 v[160:163], v204 offset:20544
    v_mfma_f32_16x16x32_bf16 v[0:3], v[232:235], v[188:191], v[0:3]
    ds_read_b128 v[164:167], v204 offset:20608
    v_mfma_f32_16x16x32_bf16 v[4:7], a[148:151], v[168:171], v[124:127]
    buffer_store_dwordx4 v[192:195], v205, s[16:19], s35 offen offset:0 sc0 sc1
    v_mfma_f32_16x16x32_bf16 v[4:7], a[172:175], v[172:175], v[4:7]
    v_mfma_f32_16x16x32_bf16 v[4:7], a[196:199], v[176:179], v[4:7]
    v_mfma_f32_16x16x32_bf16 v[4:7], a[220:223], v[180:183], v[4:7]
    v_mfma_f32_16x16x32_bf16 v[4:7], a[244:247], v[184:187], v[4:7]
    v_mfma_f32_16x16x32_bf16 v[4:7], v[236:239], v[188:191], v[4:7]
    v_mfma_f32_16x16x32_bf16 v[8:11], a[152:155], v[168:171], v[128:131]
    v_mfma_f32_16x16x32_bf16 v[8:11], a[176:179], v[172:175], v[8:11]
    buffer_store_dwordx4 v[196:199], v205, s[16:19], s35 offen offset:64 sc0 sc1
    v_mfma_f32_16x16x32_bf16 v[8:11], a[200:203], v[176:179], v[8:11]
    v_mfma_f32_16x16x32_bf16 v[8:11], a[224:227], v[180:183], v[8:11]
    v_mfma_f32_16x16x32_bf16 v[8:11], a[248:251], v[184:187], v[8:11]
    v_mfma_f32_16x16x32_bf16 v[8:11], v[240:243], v[188:191], v[8:11]
    v_mfma_f32_16x16x32_bf16 v[12:15], a[156:159], v[168:171], v[132:135]
    v_mfma_f32_16x16x32_bf16 v[12:15], a[180:183], v[172:175], v[12:15]
    v_mfma_f32_16x16x32_bf16 v[12:15], a[204:207], v[176:179], v[12:15]
    v_mfma_f32_16x16x32_bf16 v[12:15], a[228:231], v[180:183], v[12:15]
    buffer_store_dwordx4 v[200:203], v205, s[16:19], s35 offen offset:128 sc0 sc1
    v_mfma_f32_16x16x32_bf16 v[12:15], a[252:255], v[184:187], v[12:15]
    v_mfma_f32_16x16x32_bf16 v[12:15], v[244:247], v[188:191], v[12:15]
    v_mfma_f32_16x16x32_bf16 v[16:19], a[160:163], v[168:171], v[136:139]
    v_mfma_f32_16x16x32_bf16 v[16:19], a[184:187], v[172:175], v[16:19]
    v_mfma_f32_16x16x32_bf16 v[16:19], a[208:211], v[176:179], v[16:19]
    v_mfma_f32_16x16x32_bf16 v[16:19], a[232:235], v[180:183], v[16:19]
    v_mfma_f32_16x16x32_bf16 v[16:19], v[224:227], v[184:187], v[16:19]
    s_add_u32 s35, s35, 172032
    v_mfma_f32_16x16x32_bf16 v[16:19], v[248:251], v[188:191], v[16:19]
    v_mfma_f32_16x16x32_bf16 v[20:23], a[164:167], v[168:171], v[140:143]
    v_mfma_f32_16x16x32_bf16 v[20:23], a[188:191], v[172:175], v[20:23]
    v_mfma_f32_16x16x32_bf16 v[20:23], a[212:215], v[176:179], v[20:23]
    v_mfma_f32_16x16x32_bf16 v[20:23], a[236:239], v[180:183], v[20:23]
    v_mfma_f32_16x16x32_bf16 v[20:23], v[228:231], v[184:187], v[20:23]
    v_mfma_f32_16x16x32_bf16 v[20:23], v[252:255], v[188:191], v[20:23]
    s_waitcnt lgkmcnt(0)
    v_mfma_f32_16x16x32_bf16 v[0:3], a[0:3], v[144:147], v[0:3]
    ds_read_b128 v[168:171], v204 offset:24800
    v_mfma_f32_16x16x32_bf16 v[0:3], a[24:27], v[148:151], v[0:3]
    v_cvt_pk_bf16_f32 v192, v24, v25
    v_cvt_pk_bf16_f32 v193, v26, v27
    v_mfma_f32_16x16x32_bf16 v[0:3], a[48:51], v[152:155], v[0:3]
    v_mfma_f32_16x16x32_bf16 v[0:3], a[72:75], v[156:159], v[0:3]
    v_cvt_pk_bf16_f32 v194, v28, v29
    v_mfma_f32_16x16x32_bf16 v[0:3], a[96:99], v[160:163], v[0:3]
    v_mfma_f32_16x16x32_bf16 v[0:3], a[120:123], v[164:167], v[0:3]
    ds_read_b128 v[172:175], v204 offset:24864
    v_mfma_f32_16x16x32_bf16 v[4:7], a[4:7], v[144:147], v[4:7]
    v_mfma_f32_16x16x32_bf16 v[4:7], a[28:31], v[148:151], v[4:7]
    v_cvt_pk_bf16_f32 v195, v30, v31
    v_mfma_f32_16x16x32_bf16 v[4:7], a[52:55], v[152:155], v[4:7]
    v_mfma_f32_16x16x32_bf16 v[4:7], a[76:79], v[156:159], v[4:7]
    buffer_store_dwordx4 v[192:195], v205, s[16:19], s35 offen offset:0 sc0 sc1
    v_mfma_f32_16x16x32_bf16 v[4:7], a[100:103], v[160:163], v[4:7]
    v_mfma_f32_16x16x32_bf16 v[4:7], a[124:127], v[164:167], v[4:7]
    v_cvt_pk_bf16_f32 v196, v32, v33
    v_mfma_f32_16x16x32_bf16 v[8:11], a[8:11], v[144:147], v[8:11]
    v_mfma_f32_16x16x32_bf16 v[8:11], a[32:35], v[148:151], v[8:11]
    ds_read_b128 v[176:179], v204 offset:24928
    v_mfma_f32_16x16x32_bf16 v[8:11], a[56:59], v[152:155], v[8:11]
    v_mfma_f32_16x16x32_bf16 v[8:11], a[80:83], v[156:159], v[8:11]
    v_cvt_pk_bf16_f32 v197, v34, v35
    v_cvt_pk_bf16_f32 v198, v36, v37
    v_mfma_f32_16x16x32_bf16 v[8:11], a[104:107], v[160:163], v[8:11]
    v_mfma_f32_16x16x32_bf16 v[8:11], a[128:131], v[164:167], v[8:11]
    ds_read_b128 v[180:183], v204 offset:24576
    v_mfma_f32_16x16x32_bf16 v[12:15], a[12:15], v[144:147], v[12:15]
    v_cvt_pk_bf16_f32 v199, v38, v39
    v_mfma_f32_16x16x32_bf16 v[12:15], a[36:39], v[148:151], v[12:15]
    v_mfma_f32_16x16x32_bf16 v[12:15], a[60:63], v[152:155], v[12:15]
    buffer_store_dwordx4 v[196:199], v205, s[16:19], s35 offen offset:64 sc0 sc1
    v_mfma_f32_16x16x32_bf16 v[12:15], a[84:87], v[156:159], v[12:15]
    v_mfma_f32_16x16x32_bf16 v[12:15], a[108:111], v[160:163], v[12:15]
    v_cvt_pk_bf16_f32 v200, v40, v41
    v_mfma_f32_16x16x32_bf16 v[12:15], a[132:135], v[164:167], v[12:15]
    v_mfma_f32_16x16x32_bf16 v[16:19], a[16:19], v[144:147], v[16:19]
    ds_read_b128 v[184:187], v204 offset:24640
    v_mfma_f32_16x16x32_bf16 v[16:19], a[40:43], v[148:151], v[16:19]
    v_mfma_f32_16x16x32_bf16 v[16:19], a[64:67], v[152:155], v[16:19]
    v_cvt_pk_bf16_f32 v201, v42, v43
    v_cvt_pk_bf16_f32 v202, v44, v45
    v_mfma_f32_16x16x32_bf16 v[16:19], a[88:91], v[156:159], v[16:19]
    v_mfma_f32_16x16x32_bf16 v[16:19], a[112:115], v[160:163], v[16:19]
    v_cvt_pk_bf16_f32 v203, v46, v47
    v_mfma_f32_16x16x32_bf16 v[16:19], a[136:139], v[164:167], v[16:19]
    v_mfma_f32_16x16x32_bf16 v[20:23], a[20:23], v[144:147], v[20:23]
    ds_read_b128 v[188:191], v204 offset:24704
    v_mfma_f32_16x16x32_bf16 v[20:23], a[44:47], v[148:151], v[20:23]
    v_mfma_f32_16x16x32_bf16 v[20:23], a[68:71], v[152:155], v[20:23]
    buffer_store_dwordx4 v[200:203], v205, s[16:19], s35 offen offset:128 sc0 sc1
    v_mfma_f32_16x16x32_bf16 v[20:23], a[92:95], v[156:159], v[20:23]
    v_mfma_f32_16x16x32_bf16 v[20:23], a[116:119], v[160:163], v[20:23]
    s_add_u32 s35, s35, 172032
    v_mfma_f32_16x16x32_bf16 v[20:23], a[140:143], v[164:167], v[20:23]
    v_mfma_f32_16x16x32_bf16 v[24:27], a[144:147], v[144:147], v[120:123]
    v_mfma_f32_16x16x32_bf16 v[24:27], a[168:171], v[148:151], v[24:27]
    v_mfma_f32_16x16x32_bf16 v[24:27], a[192:195], v[152:155], v[24:27]
    v_mfma_f32_16x16x32_bf16 v[24:27], a[216:219], v[156:159], v[24:27]
    v_mfma_f32_16x16x32_bf16 v[24:27], a[240:243], v[160:163], v[24:27]
    v_mfma_f32_16x16x32_bf16 v[24:27], v[232:235], v[164:167], v[24:27]
    v_mfma_f32_16x16x32_bf16 v[28:31], a[148:151], v[144:147], v[124:127]
    v_cvt_pk_bf16_f32 v192, v48, v49
    v_cvt_pk_bf16_f32 v193, v50, v51
    v_mfma_f32_16x16x32_bf16 v[28:31], a[172:175], v[148:151], v[28:31]
    v_mfma_f32_16x16x32_bf16 v[28:31], a[196:199], v[152:155], v[28:31]
    v_mfma_f32_16x16x32_bf16 v[28:31], a[220:223], v[156:159], v[28:31]
    v_cvt_pk_bf16_f32 v194, v52, v53
    v_cvt_pk_bf16_f32 v195, v54, v55
    v_mfma_f32_16x16x32_bf16 v[28:31], a[244:247], v[160:163], v[28:31]
    v_mfma_f32_16x16x32_bf16 v[28:31], v[236:239], v[164:167], v[28:31]
    v_mfma_f32_16x16x32_bf16 v[32:35], a[152:155], v[144:147], v[128:131]
    buffer_store_dwordx4 v[192:195], v205, s[16:19], s35 offen offset:0 sc0 sc1
    v_mfma_f32_16x16x32_bf16 v[32:35], a[176:179], v[148:151], v[32:35]
    v_mfma_f32_16x16x32_bf16 v[32:35], a[200:203], v[152:155], v[32:35]
    v_mfma_f32_16x16x32_bf16 v[32:35], a[224:227], v[156:159], v[32:35]
    v_cvt_pk_bf16_f32 v196, v56, v57
    v_cvt_pk_bf16_f32 v197, v58, v59
    v_mfma_f32_16x16x32_bf16 v[32:35], a[248:251], v[160:163], v[32:35]
    v_mfma_f32_16x16x32_bf16 v[32:35], v[240:243], v[164:167], v[32:35]
    v_mfma_f32_16x16x32_bf16 v[36:39], a[156:159], v[144:147], v[132:135]
    v_cvt_pk_bf16_f32 v198, v60, v61
    v_cvt_pk_bf16_f32 v199, v62, v63
    v_mfma_f32_16x16x32_bf16 v[36:39], a[180:183], v[148:151], v[36:39]
    v_mfma_f32_16x16x32_bf16 v[36:39], a[204:207], v[152:155], v[36:39]
    v_mfma_f32_16x16x32_bf16 v[36:39], a[228:231], v[156:159], v[36:39]
    buffer_store_dwordx4 v[196:199], v205, s[16:19], s35 offen offset:64 sc0 sc1
    v_mfma_f32_16x16x32_bf16 v[36:39], a[252:255], v[160:163], v[36:39]
    v_mfma_f32_16x16x32_bf16 v[36:39], v[244:247], v[164:167], v[36:39]
    v_mfma_f32_16x16x32_bf16 v[40:43], a[160:163], v[144:147], v[136:139]
    v_cvt_pk_bf16_f32 v200, v64, v65
    v_cvt_pk_bf16_f32 v201, v66, v67
    v_mfma_f32_16x16x32_bf16 v[40:43], a[184:187], v[148:151], v[40:43]
    v_mfma_f32_16x16x32_bf16 v[40:43], a[208:211], v[152:155], v[40:43]
    v_mfma_f32_16x16x32_bf16 v[40:43], a[232:235], v[156:159], v[40:43]
    v_cvt_pk_bf16_f32 v202, v68, v69
    v_cvt_pk_bf16_f32 v203, v70, v71
    v_mfma_f32_16x16x32_bf16 v[40:43], v[224:227], v[160:163], v[40:43]
    v_mfma_f32_16x16x32_bf16 v[40:43], v[248:251], v[164:167], v[40:43]
    v_mfma_f32_16x16x32_bf16 v[44:47], a[164:167], v[144:147], v[140:143]
    buffer_store_dwordx4 v[200:203], v205, s[16:19], s35 offen offset:128 sc0 sc1
    v_mfma_f32_16x16x32_bf16 v[44:47], a[188:191], v[148:151], v[44:47]
    v_mfma_f32_16x16x32_bf16 v[44:47], a[212:215], v[152:155], v[44:47]
    v_mfma_f32_16x16x32_bf16 v[44:47], a[236:239], v[156:159], v[44:47]
    s_add_u32 s35, s35, 172032
    v_mfma_f32_16x16x32_bf16 v[44:47], v[228:231], v[160:163], v[44:47]
    v_mfma_f32_16x16x32_bf16 v[44:47], v[252:255], v[164:167], v[44:47]
    s_waitcnt lgkmcnt(0)
    v_mfma_f32_16x16x32_bf16 v[24:27], a[0:3], v[168:171], v[24:27]
    ds_read_b128 v[144:147], v204 offset:28896
    v_mfma_f32_16x16x32_bf16 v[24:27], a[24:27], v[172:175], v[24:27]
    v_cvt_pk_bf16_f32 v192, v72, v73
    v_cvt_pk_bf16_f32 v193, v74, v75
    v_mfma_f32_16x16x32_bf16 v[24:27], a[48:51], v[176:179], v[24:27]
    v_mfma_f32_16x16x32_bf16 v[24:27], a[72:75], v[180:183], v[24:27]
    v_cvt_pk_bf16_f32 v194, v76, v77
    v_mfma_f32_16x16x32_bf16 v[24:27], a[96:99], v[184:187], v[24:27]
    v_mfma_f32_16x16x32_bf16 v[24:27], a[120:123], v[188:191], v[24:27]
    ds_read_b128 v[148:151], v204 offset:28960
    v_mfma_f32_16x16x32_bf16 v[28:31], a[4:7], v[168:171], v[28:31]
    v_mfma_f32_16x16x32_bf16 v[28:31], a[28:31], v[172:175], v[28:31]
    v_cvt_pk_bf16_f32 v195, v78, v79
    v_mfma_f32_16x16x32_bf16 v[28:31], a[52:55], v[176:179], v[28:31]
    v_mfma_f32_16x16x32_bf16 v[28:31], a[76:79], v[180:183], v[28:31]
    buffer_store_dwordx4 v[192:195], v205, s[16:19], s35 offen offset:0 sc0 sc1
    v_mfma_f32_16x16x32_bf16 v[28:31], a[100:103], v[184:187], v[28:31]
    v_mfma_f32_16x16x32_bf16 v[28:31], a[124:127], v[188:191], v[28:31]
    v_cvt_pk_bf16_f32 v196, v80, v81
    v_mfma_f32_16x16x32_bf16 v[32:35], a[8:11], v[168:171], v[32:35]
    v_mfma_f32_16x16x32_bf16 v[32:35], a[32:35], v[172:175], v[32:35]
    ds_read_b128 v[152:155], v204 offset:29024
    v_mfma_f32_16x16x32_bf16 v[32:35], a[56:59], v[176:179], v[32:35]
    v_mfma_f32_16x16x32_bf16 v[32:35], a[80:83], v[180:183], v[32:35]
    v_cvt_pk_bf16_f32 v197, v82, v83
    v_cvt_pk_bf16_f32 v198, v84, v85
    v_mfma_f32_16x16x32_bf16 v[32:35], a[104:107], v[184:187], v[32:35]
    v_mfma_f32_16x16x32_bf16 v[32:35], a[128:131], v[188:191], v[32:35]
    ds_read_b128 v[156:159], v204 offset:28672
    v_mfma_f32_16x16x32_bf16 v[36:39], a[12:15], v[168:171], v[36:39]
    v_cvt_pk_bf16_f32 v199, v86, v87
    v_mfma_f32_16x16x32_bf16 v[36:39], a[36:39], v[172:175], v[36:39]
    v_mfma_f32_16x16x32_bf16 v[36:39], a[60:63], v[176:179], v[36:39]
    buffer_store_dwordx4 v[196:199], v205, s[16:19], s35 offen offset:64 sc0 sc1
    v_mfma_f32_16x16x32_bf16 v[36:39], a[84:87], v[180:183], v[36:39]
    v_mfma_f32_16x16x32_bf16 v[36:39], a[108:111], v[184:187], v[36:39]
    v_cvt_pk_bf16_f32 v200, v88, v89
    v_mfma_f32_16x16x32_bf16 v[36:39], a[132:135], v[188:191], v[36:39]
    v_mfma_f32_16x16x32_bf16 v[40:43], a[16:19], v[168:171], v[40:43]
    ds_read_b128 v[160:163], v204 offset:28736
    v_mfma_f32_16x16x32_bf16 v[40:43], a[40:43], v[172:175], v[40:43]
    v_mfma_f32_16x16x32_bf16 v[40:43], a[64:67], v[176:179], v[40:43]
    v_cvt_pk_bf16_f32 v201, v90, v91
    v_cvt_pk_bf16_f32 v202, v92, v93
    v_mfma_f32_16x16x32_bf16 v[40:43], a[88:91], v[180:183], v[40:43]
    v_mfma_f32_16x16x32_bf16 v[40:43], a[112:115], v[184:187], v[40:43]
    v_cvt_pk_bf16_f32 v203, v94, v95
    v_mfma_f32_16x16x32_bf16 v[40:43], a[136:139], v[188:191], v[40:43]
    v_mfma_f32_16x16x32_bf16 v[44:47], a[20:23], v[168:171], v[44:47]
    ds_read_b128 v[164:167], v204 offset:28800
    v_mfma_f32_16x16x32_bf16 v[44:47], a[44:47], v[172:175], v[44:47]
    v_mfma_f32_16x16x32_bf16 v[44:47], a[68:71], v[176:179], v[44:47]
    buffer_store_dwordx4 v[200:203], v205, s[16:19], s35 offen offset:128 sc0 sc1
    v_mfma_f32_16x16x32_bf16 v[44:47], a[92:95], v[180:183], v[44:47]
    v_mfma_f32_16x16x32_bf16 v[44:47], a[116:119], v[184:187], v[44:47]
    s_add_u32 s35, s35, 172032
    v_mfma_f32_16x16x32_bf16 v[44:47], a[140:143], v[188:191], v[44:47]
    v_mfma_f32_16x16x32_bf16 v[48:51], a[144:147], v[168:171], v[120:123]
    v_mfma_f32_16x16x32_bf16 v[48:51], a[168:171], v[172:175], v[48:51]
    v_mfma_f32_16x16x32_bf16 v[48:51], a[192:195], v[176:179], v[48:51]
    v_mfma_f32_16x16x32_bf16 v[48:51], a[216:219], v[180:183], v[48:51]
    v_mfma_f32_16x16x32_bf16 v[48:51], a[240:243], v[184:187], v[48:51]
    v_mfma_f32_16x16x32_bf16 v[48:51], v[232:235], v[188:191], v[48:51]
    v_mfma_f32_16x16x32_bf16 v[52:55], a[148:151], v[168:171], v[124:127]
    v_cvt_pk_bf16_f32 v192, v0, v1
    v_cvt_pk_bf16_f32 v193, v2, v3
    v_mfma_f32_16x16x32_bf16 v[52:55], a[172:175], v[172:175], v[52:55]
    v_mfma_f32_16x16x32_bf16 v[52:55], a[196:199], v[176:179], v[52:55]
    v_mfma_f32_16x16x32_bf16 v[52:55], a[220:223], v[180:183], v[52:55]
    v_cvt_pk_bf16_f32 v194, v4, v5
    v_cvt_pk_bf16_f32 v195, v6, v7
    v_mfma_f32_16x16x32_bf16 v[52:55], a[244:247], v[184:187], v[52:55]
    v_mfma_f32_16x16x32_bf16 v[52:55], v[236:239], v[188:191], v[52:55]
    v_mfma_f32_16x16x32_bf16 v[56:59], a[152:155], v[168:171], v[128:131]
    buffer_store_dwordx4 v[192:195], v205, s[16:19], s35 offen offset:0 sc0 sc1
    v_mfma_f32_16x16x32_bf16 v[56:59], a[176:179], v[172:175], v[56:59]
    v_mfma_f32_16x16x32_bf16 v[56:59], a[200:203], v[176:179], v[56:59]
    v_mfma_f32_16x16x32_bf16 v[56:59], a[224:227], v[180:183], v[56:59]
    v_cvt_pk_bf16_f32 v196, v8, v9
    v_cvt_pk_bf16_f32 v197, v10, v11
    v_mfma_f32_16x16x32_bf16 v[56:59], a[248:251], v[184:187], v[56:59]
    v_mfma_f32_16x16x32_bf16 v[56:59], v[240:243], v[188:191], v[56:59]
    v_mfma_f32_16x16x32_bf16 v[60:63], a[156:159], v[168:171], v[132:135]
    v_cvt_pk_bf16_f32 v198, v12, v13
    v_cvt_pk_bf16_f32 v199, v14, v15
    v_mfma_f32_16x16x32_bf16 v[60:63], a[180:183], v[172:175], v[60:63]
    v_mfma_f32_16x16x32_bf16 v[60:63], a[204:207], v[176:179], v[60:63]
    v_mfma_f32_16x16x32_bf16 v[60:63], a[228:231], v[180:183], v[60:63]
    buffer_store_dwordx4 v[196:199], v205, s[16:19], s35 offen offset:64 sc0 sc1
    v_mfma_f32_16x16x32_bf16 v[60:63], a[252:255], v[184:187], v[60:63]
    v_mfma_f32_16x16x32_bf16 v[60:63], v[244:247], v[188:191], v[60:63]
    v_mfma_f32_16x16x32_bf16 v[64:67], a[160:163], v[168:171], v[136:139]
    v_cvt_pk_bf16_f32 v200, v16, v17
    v_cvt_pk_bf16_f32 v201, v18, v19
    v_mfma_f32_16x16x32_bf16 v[64:67], a[184:187], v[172:175], v[64:67]
    v_mfma_f32_16x16x32_bf16 v[64:67], a[208:211], v[176:179], v[64:67]
    v_mfma_f32_16x16x32_bf16 v[64:67], a[232:235], v[180:183], v[64:67]
    v_cvt_pk_bf16_f32 v202, v20, v21
    v_cvt_pk_bf16_f32 v203, v22, v23
    v_mfma_f32_16x16x32_bf16 v[64:67], v[224:227], v[184:187], v[64:67]
    v_mfma_f32_16x16x32_bf16 v[64:67], v[248:251], v[188:191], v[64:67]
    v_mfma_f32_16x16x32_bf16 v[68:71], a[164:167], v[168:171], v[140:143]
    buffer_store_dwordx4 v[200:203], v205, s[16:19], s35 offen offset:128 sc0 sc1
    v_mfma_f32_16x16x32_bf16 v[68:71], a[188:191], v[172:175], v[68:71]
    v_mfma_f32_16x16x32_bf16 v[68:71], a[212:215], v[176:179], v[68:71]
    v_mfma_f32_16x16x32_bf16 v[68:71], a[236:239], v[180:183], v[68:71]
    s_add_u32 s35, s35, 172032
    v_mfma_f32_16x16x32_bf16 v[68:71], v[228:231], v[184:187], v[68:71]
    v_mfma_f32_16x16x32_bf16 v[68:71], v[252:255], v[188:191], v[68:71]
    s_waitcnt lgkmcnt(0)
    v_mfma_f32_16x16x32_bf16 v[48:51], a[0:3], v[144:147], v[48:51]
    ds_read_b128 v[168:171], v204 offset:32992
    v_mfma_f32_16x16x32_bf16 v[48:51], a[24:27], v[148:151], v[48:51]
    v_cvt_pk_bf16_f32 v192, v24, v25
    v_cvt_pk_bf16_f32 v193, v26, v27
    v_mfma_f32_16x16x32_bf16 v[48:51], a[48:51], v[152:155], v[48:51]
    v_mfma_f32_16x16x32_bf16 v[48:51], a[72:75], v[156:159], v[48:51]
    v_cvt_pk_bf16_f32 v194, v28, v29
    v_mfma_f32_16x16x32_bf16 v[48:51], a[96:99], v[160:163], v[48:51]
    v_mfma_f32_16x16x32_bf16 v[48:51], a[120:123], v[164:167], v[48:51]
    ds_read_b128 v[172:175], v204 offset:33056
    v_mfma_f32_16x16x32_bf16 v[52:55], a[4:7], v[144:147], v[52:55]
    v_mfma_f32_16x16x32_bf16 v[52:55], a[28:31], v[148:151], v[52:55]
    v_cvt_pk_bf16_f32 v195, v30, v31
    v_mfma_f32_16x16x32_bf16 v[52:55], a[52:55], v[152:155], v[52:55]
    v_mfma_f32_16x16x32_bf16 v[52:55], a[76:79], v[156:159], v[52:55]
    buffer_store_dwordx4 v[192:195], v205, s[16:19], s35 offen offset:0 sc0 sc1
    v_mfma_f32_16x16x32_bf16 v[52:55], a[100:103], v[160:163], v[52:55]
    v_cvt_pk_bf16_f32 v196, v32, v33
    v_mfma_f32_16x16x32_bf16 v[52:55], a[124:127], v[164:167], v[52:55]
    v_mfma_f32_16x16x32_bf16 v[56:59], a[8:11], v[144:147], v[56:59]
    ds_read_b128 v[176:179], v204 offset:33120
    v_mfma_f32_16x16x32_bf16 v[56:59], a[32:35], v[148:151], v[56:59]
    v_mfma_f32_16x16x32_bf16 v[56:59], a[56:59], v[152:155], v[56:59]
    v_cvt_pk_bf16_f32 v197, v34, v35
    v_cvt_pk_bf16_f32 v198, v36, v37
    v_mfma_f32_16x16x32_bf16 v[56:59], a[80:83], v[156:159], v[56:59]
    v_mfma_f32_16x16x32_bf16 v[56:59], a[104:107], v[160:163], v[56:59]
    ds_read_b128 v[180:183], v204 offset:32768
    v_mfma_f32_16x16x32_bf16 v[56:59], a[128:131], v[164:167], v[56:59]
    v_mfma_f32_16x16x32_bf16 v[60:63], a[12:15], v[144:147], v[60:63]
    v_cvt_pk_bf16_f32 v199, v38, v39
    v_mfma_f32_16x16x32_bf16 v[60:63], a[36:39], v[148:151], v[60:63]
    buffer_store_dwordx4 v[196:199], v205, s[16:19], s35 offen offset:64 sc0 sc1
    v_mfma_f32_16x16x32_bf16 v[60:63], a[60:63], v[152:155], v[60:63]
    v_mfma_f32_16x16x32_bf16 v[60:63], a[84:87], v[156:159], v[60:63]
    v_cvt_pk_bf16_f32 v200, v40, v41
    v_mfma_f32_16x16x32_bf16 v[60:63], a[108:111], v[160:163], v[60:63]
    v_mfma_f32_16x16x32_bf16 v[60:63], a[132:135], v[164:167], v[60:63]
    ds_read_b128 v[184:187], v204 offset:32832
    v_mfma_f32_16x16x32_bf16 v[64:67], a[16:19], v[144:147], v[64:67]
    v_mfma_f32_16x16x32_bf16 v[64:67], a[40:43], v[148:151], v[64:67]
    v_cvt_pk_bf16_f32 v201, v42, v43
    v_cvt_pk_bf16_f32 v202, v44, v45
    v_mfma_f32_16x16x32_bf16 v[64:67], a[64:67], v[152:155], v[64:67]
    v_mfma_f32_16x16x32_bf16 v[64:67], a[88:91], v[156:159], v[64:67]
    v_cvt_pk_bf16_f32 v203, v46, v47
    v_mfma_f32_16x16x32_bf16 v[64:67], a[112:115], v[160:163], v[64:67]
    ds_read_b128 v[188:191], v204 offset:32896
    v_mfma_f32_16x16x32_bf16 v[64:67], a[136:139], v[164:167], v[64:67]
    v_mfma_f32_16x16x32_bf16 v[68:71], a[20:23], v[144:147], v[68:71]
    buffer_store_dwordx4 v[200:203], v205, s[16:19], s35 offen offset:128 sc0 sc1
    v_mfma_f32_16x16x32_bf16 v[68:71], a[44:47], v[148:151], v[68:71]
    v_mfma_f32_16x16x32_bf16 v[68:71], a[68:71], v[152:155], v[68:71]
    s_add_u32 s35, s35, 172032
    s_sub_u32 s41, s34, 7
    v_mfma_f32_16x16x32_bf16 v[68:71], a[92:95], v[156:159], v[68:71]
    v_mfma_f32_16x16x32_bf16 v[68:71], a[116:119], v[160:163], v[68:71]
    v_add_u32 v204, 28672, v204
    v_mfma_f32_16x16x32_bf16 v[68:71], a[140:143], v[164:167], v[68:71]
L_loop:
    v_mfma_f32_16x16x32_bf16 v[72:75], a[144:147], v[144:147], v[120:123]
    v_mfma_f32_16x16x32_bf16 v[72:75], a[168:171], v[148:151], v[72:75]
    v_mfma_f32_16x16x32_bf16 v[72:75], a[192:195], v[152:155], v[72:75]
    v_mfma_f32_16x16x32_bf16 v[72:75], a[216:219], v[156:159], v[72:75]
    v_mfma_f32_16x16x32_bf16 v[72:75], a[240:243], v[160:163], v[72:75]
    v_mfma_f32_16x16x32_bf16 v[72:75], v[232:235], v[164:167], v[72:75]
    v_mfma_f32_16x16x32_bf16 v[76:79], a[148:151], v[144:147], v[124:127]
    v_cvt_pk_bf16_f32 v192, v48, v49
    v_cvt_pk_bf16_f32 v193, v50, v51
    v_mfma_f32_16x16x32_bf16 v[76:79], a[172:175], v[148:151], v[76:79]
    v_mfma_f32_16x16x32_bf16 v[76:79], a[196:199], v[152:155], v[76:79]
    v_mfma_f32_16x16x32_bf16 v[76:79], a[220:223], v[156:159], v[76:79]
    v_cvt_pk_bf16_f32 v194, v52, v53
    v_cvt_pk_bf16_f32 v195, v54, v55
    v_mfma_f32_16x16x32_bf16 v[76:79], a[244:247], v[160:163], v[76:79]
    v_mfma_f32_16x16x32_bf16 v[76:79], v[236:239], v[164:167], v[76:79]
    v_mfma_f32_16x16x32_bf16 v[80:83], a[152:155], v[144:147], v[128:131]
    buffer_store_dwordx4 v[192:195], v205, s[16:19], s35 offen offset:0 sc0 sc1
    v_mfma_f32_16x16x32_bf16 v[80:83], a[176:179], v[148:151], v[80:83]
    v_mfma_f32_16x16x32_bf16 v[80:83], a[200:203], v[152:155], v[80:83]
    v_mfma_f32_16x16x32_bf16 v[80:83], a[224:227], v[156:159], v[80:83]
    v_cvt_pk_bf16_f32 v196, v56, v57
    v_cvt_pk_bf16_f32 v197, v58, v59
    v_mfma_f32_16x16x32_bf16 v[80:83], a[248:251], v[160:163], v[80:83]
    v_mfma_f32_16x16x32_bf16 v[80:83], v[240:243], v[164:167], v[80:83]
    v_mfma_f32_16x16x32_bf16 v[84:87], a[156:159], v[144:147], v[132:135]
    v_cvt_pk_bf16_f32 v198, v60, v61
    v_cvt_pk_bf16_f32 v199, v62, v63
    v_mfma_f32_16x16x32_bf16 v[84:87], a[180:183], v[148:151], v[84:87]
    v_mfma_f32_16x16x32_bf16 v[84:87], a[204:207], v[152:155], v[84:87]
    v_mfma_f32_16x16x32_bf16 v[84:87], a[228:231], v[156:159], v[84:87]
    buffer_store_dwordx4 v[196:199], v205, s[16:19], s35 offen offset:64 sc0 sc1
    v_mfma_f32_16x16x32_bf16 v[84:87], a[252:255], v[160:163], v[84:87]
    v_mfma_f32_16x16x32_bf16 v[84:87], v[244:247], v[164:167], v[84:87]
    v_mfma_f32_16x16x32_bf16 v[88:91], a[160:163], v[144:147], v[136:139]
    v_cvt_pk_bf16_f32 v200, v64, v65
    v_cvt_pk_bf16_f32 v201, v66, v67
    v_mfma_f32_16x16x32_bf16 v[88:91], a[184:187], v[148:151], v[88:91]
    v_mfma_f32_16x16x32_bf16 v[88:91], a[208:211], v[152:155], v[88:91]
    v_mfma_f32_16x16x32_bf16 v[88:91], a[232:235], v[156:159], v[88:91]
    v_cvt_pk_bf16_f32 v202, v68, v69
    v_cvt_pk_bf16_f32 v203, v70, v71
    v_mfma_f32_16x16x32_bf16 v[88:91], v[224:227], v[160:163], v[88:91]
    v_mfma_f32_16x16x32_bf16 v[88:91], v[248:251], v[164:167], v[88:91]
    v_mfma_f32_16x16x32_bf16 v[92:95], a[164:167], v[144:147], v[140:143]
    buffer_store_dwordx4 v[200:203], v205, s[16:19], s35 offen offset:128 sc0 sc1
    v_mfma_f32_16x16x32_bf16 v[92:95], a[188:191], v[148:151], v[92:95]
    v_mfma_f32_16x16x32_bf16 v[92:95], a[212:215], v[152:155], v[92:95]
    v_mfma_f32_16x16x32_bf16 v[92:95], a[236:239], v[156:159], v[92:95]
    s_add_u32 s35, s35, 172032
    v_mfma_f32_16x16x32_bf16 v[92:95], v[228:231], v[160:163], v[92:95]
    v_mfma_f32_16x16x32_bf16 v[92:95], v[252:255], v[164:167], v[92:95]
    s_waitcnt lgkmcnt(0)
    v_mfma_f32_16x16x32_bf16 v[72:75], a[0:3], v[168:171], v[72:75]
    ds_read_b128 v[144:147], v204 offset:8416
    v_mfma_f32_16x16x32_bf16 v[72:75], a[24:27], v[172:175], v[72:75]
    v_mfma_f32_16x16x32_bf16 v[72:75], a[48:51], v[176:179], v[72:75]
    v_mfma_f32_16x16x32_bf16 v[72:75], a[72:75], v[180:183], v[72:75]
    v_mfma_f32_16x16x32_bf16 v[72:75], a[96:99], v[184:187], v[72:75]
    v_mfma_f32_16x16x32_bf16 v[72:75], a[120:123], v[188:191], v[72:75]
    ds_read_b128 v[148:151], v204 offset:8480
    v_mfma_f32_16x16x32_bf16 v[76:79], a[4:7], v[168:171], v[76:79]
    v_mfma_f32_16x16x32_bf16 v[76:79], a[28:31], v[172:175], v[76:79]
    v_mfma_f32_16x16x32_bf16 v[76:79], a[52:55], v[176:179], v[76:79]
    v_mfma_f32_16x16x32_bf16 v[76:79], a[76:79], v[180:183], v[76:79]
    v_mfma_f32_16x16x32_bf16 v[76:79], a[100:103], v[184:187], v[76:79]
    ds_read_b128 v[152:155], v204 offset:8544
    v_mfma_f32_16x16x32_bf16 v[76:79], a[124:127], v[188:191], v[76:79]
    v_mfma_f32_16x16x32_bf16 v[80:83], a[8:11], v[168:171], v[80:83]
    v_mfma_f32_16x16x32_bf16 v[80:83], a[32:35], v[172:175], v[80:83]
    v_mfma_f32_16x16x32_bf16 v[80:83], a[56:59], v[176:179], v[80:83]
    v_mfma_f32_16x16x32_bf16 v[80:83], a[80:83], v[180:183], v[80:83]
    ds_read_b128 v[156:159], v204 offset:8192
    v_mfma_f32_16x16x32_bf16 v[80:83], a[104:107], v[184:187], v[80:83]
    v_mfma_f32_16x16x32_bf16 v[80:83], a[128:131], v[188:191], v[80:83]
    v_mfma_f32_16x16x32_bf16 v[84:87], a[12:15], v[168:171], v[84:87]
    v_mfma_f32_16x16x32_bf16 v[84:87], a[36:39], v[172:175], v[84:87]
    v_mfma_f32_16x16x32_bf16 v[84:87], a[60:63], v[176:179], v[84:87]
    ds_read_b128 v[160:163], v204 offset:8256
    v_mfma_f32_16x16x32_bf16 v[84:87], a[84:87], v[180:183], v[84:87]
    v_mfma_f32_16x16x32_bf16 v[84:87], a[108:111], v[184:187], v[84:87]
    v_mfma_f32_16x16x32_bf16 v[84:87], a[132:135], v[188:191], v[84:87]
    v_mfma_f32_16x16x32_bf16 v[88:91], a[16:19], v[168:171], v[88:91]
    v_mfma_f32_16x16x32_bf16 v[88:91], a[40:43], v[172:175], v[88:91]
    ds_read_b128 v[164:167], v204 offset:8320
    v_mfma_f32_16x16x32_bf16 v[88:91], a[64:67], v[176:179], v[88:91]
    v_mfma_f32_16x16x32_bf16 v[88:91], a[88:91], v[180:183], v[88:91]
    v_mfma_f32_16x16x32_bf16 v[88:91], a[112:115], v[184:187], v[88:91]
    v_mfma_f32_16x16x32_bf16 v[88:91], a[136:139], v[188:191], v[88:91]
    v_mfma_f32_16x16x32_bf16 v[92:95], a[20:23], v[168:171], v[92:95]
    s_sub_u32 s41, s41, 1
    s_cmp_eq_u32 s41, 0
    v_mfma_f32_16x16x32_bf16 v[92:95], a[44:47], v[172:175], v[92:95]
    v_mfma_f32_16x16x32_bf16 v[92:95], a[68:71], v[176:179], v[92:95]
    v_mfma_f32_16x16x32_bf16 v[92:95], a[92:95], v[180:183], v[92:95]
    v_mfma_f32_16x16x32_bf16 v[92:95], a[116:119], v[184:187], v[92:95]
    v_mfma_f32_16x16x32_bf16 v[92:95], a[140:143], v[188:191], v[92:95]
    s_cbranch_scc1 L_fin1
    v_mfma_f32_16x16x32_bf16 v[48:51], a[144:147], v[168:171], v[120:123]
    v_mfma_f32_16x16x32_bf16 v[48:51], a[168:171], v[172:175], v[48:51]
    v_mfma_f32_16x16x32_bf16 v[48:51], a[192:195], v[176:179], v[48:51]
    v_mfma_f32_16x16x32_bf16 v[48:51], a[216:219], v[180:183], v[48:51]
    v_mfma_f32_16x16x32_bf16 v[48:51], a[240:243], v[184:187], v[48:51]
    v_mfma_f32_16x16x32_bf16 v[48:51], v[232:235], v[188:191], v[48:51]
    v_mfma_f32_16x16x32_bf16 v[52:55], a[148:151], v[168:171], v[124:127]
    v_cvt_pk_bf16_f32 v192, v72, v73
    v_cvt_pk_bf16_f32 v193, v74, v75
    v_mfma_f32_16x16x32_bf16 v[52:55], a[172:175], v[172:175], v[52:55]
    v_mfma_f32_16x16x32_bf16 v[52:55], a[196:199], v[176:179], v[52:55]
    v_mfma_f32_16x16x32_bf16 v[52:55], a[220:223], v[180:183], v[52:55]
    v_cvt_pk_bf16_f32 v194, v76, v77
    v_cvt_pk_bf16_f32 v195, v78, v79
    v_mfma_f32_16x16x32_bf16 v[52:55], a[244:247], v[184:187], v[52:55]
    v_mfma_f32_16x16x32_bf16 v[52:55], v[236:239], v[188:191], v[52:55]
    v_mfma_f32_16x16x32_bf16 v[56:59], a[152:155], v[168:171], v[128:131]
    buffer_store_dwordx4 v[192:195], v205, s[16:19], s35 offen offset:0 sc0 sc1
    v_mfma_f32_16x16x32_bf16 v[56:59], a[176:179], v[172:175], v[56:59]
    v_mfma_f32_16x16x32_bf16 v[56:59], a[200:203], v[176:179], v[56:59]
    v_mfma_f32_16x16x32_bf16 v[56:59], a[224:227], v[180:183], v[56:59]
    v_cvt_pk_bf16_f32 v196, v80, v81
    v_cvt_pk_bf16_f32 v197, v82, v83
    v_mfma_f32_16x16x32_bf16 v[56:59], a[248:251], v[184:187], v[56:59]
    v_mfma_f32_16x16x32_bf16 v[56:59], v[240:243], v[188:191], v[56:59]
    v_mfma_f32_16x16x32_bf16 v[60:63], a[156:159], v[168:171], v[132:135]
    v_cvt_pk_bf16_f32 v198, v84, v85
    v_cvt_pk_bf16_f32 v199, v86, v87
    v_mfma_f32_16x16x32_bf16 v[60:63], a[180:183], v[172:175], v[60:63]
    v_mfma_f32_16x16x32_bf16 v[60:63], a[204:207], v[176:179], v[60:63]
    v_mfma_f32_16x16x32_bf16 v[60:63], a[228:231], v[180:183], v[60:63]
    buffer_store_dwordx4 v[196:199], v205, s[16:19], s35 offen offset:64 sc0 sc1
    v_mfma_f32_16x16x32_bf16 v[60:63], a[252:255], v[184:187], v[60:63]
    v_mfma_f32_16x16x32_bf16 v[60:63], v[244:247], v[188:191], v[60:63]
    v_mfma_f32_16x16x32_bf16 v[64:67], a[160:163], v[168:171], v[136:139]
    v_cvt_pk_bf16_f32 v200, v88, v89
    v_cvt_pk_bf16_f32 v201, v90, v91
    v_mfma_f32_16x16x32_bf16 v[64:67], a[184:187], v[172:175], v[64:67]
    v_mfma_f32_16x16x32_bf16 v[64:67], a[208:211], v[176:179], v[64:67]
    v_mfma_f32_16x16x32_bf16 v[64:67], a[232:235], v[180:183], v[64:67]
    v_cvt_pk_bf16_f32 v202, v92, v93
    v_cvt_pk_bf16_f32 v203, v94, v95
    v_mfma_f32_16x16x32_bf16 v[64:67], v[224:227], v[184:187], v[64:67]
    v_mfma_f32_16x16x32_bf16 v[64:67], v[248:251], v[188:191], v[64:67]
    v_mfma_f32_16x16x32_bf16 v[68:71], a[164:167], v[168:171], v[140:143]
    buffer_store_dwordx4 v[200:203], v205, s[16:19], s35 offen offset:128 sc0 sc1
    v_mfma_f32_16x16x32_bf16 v[68:71], a[188:191], v[172:175], v[68:71]
    v_mfma_f32_16x16x32_bf16 v[68:71], a[212:215], v[176:179], v[68:71]
    v_mfma_f32_16x16x32_bf16 v[68:71], a[236:239], v[180:183], v[68:71]
    s_add_u32 s35, s35, 172032
    v_mfma_f32_16x16x32_bf16 v[68:71], v[228:231], v[184:187], v[68:71]
    v_mfma_f32_16x16x32_bf16 v[68:71], v[252:255], v[188:191], v[68:71]
    s_waitcnt lgkmcnt(0)
    v_mfma_f32_16x16x32_bf16 v[48:51], a[0:3], v[144:147], v[48:51]
    ds_read_b128 v[168:171], v204 offset:12512
    v_mfma_f32_16x16x32_bf16 v[48:51], a[24:27], v[148:151], v[48:51]
    v_mfma_f32_16x16x32_bf16 v[48:51], a[48:51], v[152:155], v[48:51]
    v_mfma_f32_16x16x32_bf16 v[48:51], a[72:75], v[156:159], v[48:51]
    v_mfma_f32_16x16x32_bf16 v[48:51], a[96:99], v[160:163], v[48:51]
    ds_read_b128 v[172:175], v204 offset:12576
    v_mfma_f32_16x16x32_bf16 v[48:51], a[120:123], v[164:167], v[48:51]
    v_mfma_f32_16x16x32_bf16 v[52:55], a[4:7], v[144:147], v[52:55]
    v_mfma_f32_16x16x32_bf16 v[52:55], a[28:31], v[148:151], v[52:55]
    v_mfma_f32_16x16x32_bf16 v[52:55], a[52:55], v[152:155], v[52:55]
    v_mfma_f32_16x16x32_bf16 v[52:55], a[76:79], v[156:159], v[52:55]
    ds_read_b128 v[176:179], v204 offset:12640
    v_mfma_f32_16x16x32_bf16 v[52:55], a[100:103], v[160:163], v[52:55]
    v_mfma_f32_16x16x32_bf16 v[52:55], a[124:127], v[164:167], v[52:55]
    v_mfma_f32_16x16x32_bf16 v[56:59], a[8:11], v[144:147], v[56:59]
    v_mfma_f32_16x16x32_bf16 v[56:59], a[32:35], v[148:151], v[56:59]
    ds_read_b128 v[180:183], v204 offset:12288
    v_mfma_f32_16x16x32_bf16 v[56:59], a[56:59], v[152:155], v[56:59]
    v_mfma_f32_16x16x32_bf16 v[56:59], a[80:83], v[156:159], v[56:59]
    v_mfma_f32_16x16x32_bf16 v[56:59], a[104:107], v[160:163], v[56:59]
    v_mfma_f32_16x16x32_bf16 v[56:59], a[128:131], v[164:167], v[56:59]
    v_mfma_f32_16x16x32_bf16 v[60:63], a[12:15], v[144:147], v[60:63]
    ds_read_b128 v[184:187], v204 offset:12352
    v_mfma_f32_16x16x32_bf16 v[60:63], a[36:39], v[148:151], v[60:63]
    v_mfma_f32_16x16x32_bf16 v[60:63], a[60:63], v[152:155], v[60:63]
    v_mfma_f32_16x16x32_bf16 v[60:63], a[84:87], v[156:159], v[60:63]
    v_mfma_f32_16x16x32_bf16 v[60:63], a[108:111], v[160:163], v[60:63]
    ds_read_b128 v[188:191], v204 offset:12416
    v_mfma_f32_16x16x32_bf16 v[60:63], a[132:135], v[164:167], v[60:63]
    v_mfma_f32_16x16x32_bf16 v[64:67], a[16:19], v[144:147], v[64:67]
    v_mfma_f32_16x16x32_bf16 v[64:67], a[40:43], v[148:151], v[64:67]
    v_mfma_f32_16x16x32_bf16 v[64:67], a[64:67], v[152:155], v[64:67]
    v_mfma_f32_16x16x32_bf16 v[64:67], a[88:91], v[156:159], v[64:67]
    v_add_u32 v204, 8192, v204
    s_sub_u32 s41, s41, 1
    v_mfma_f32_16x16x32_bf16 v[64:67], a[112:115], v[160:163], v[64:67]
    v_mfma_f32_16x16x32_bf16 v[64:67], a[136:139], v[164:167], v[64:67]
    v_mfma_f32_16x16x32_bf16 v[68:71], a[20:23], v[144:147], v[68:71]
    v_mfma_f32_16x16x32_bf16 v[68:71], a[44:47], v[148:151], v[68:71]
    s_cmp_eq_u32 s41, 0
    v_mfma_f32_16x16x32_bf16 v[68:71], a[68:71], v[152:155], v[68:71]
    v_mfma_f32_16x16x32_bf16 v[68:71], a[92:95], v[156:159], v[68:71]
    v_mfma_f32_16x16x32_bf16 v[68:71], a[116:119], v[160:163], v[68:71]
    v_mfma_f32_16x16x32_bf16 v[68:71], a[140:143], v[164:167], v[68:71]
    s_cbranch_scc0 L_loop
    ds_read_b128 v[144:147], v214 offset:224
    ds_read_b128 v[148:151], v214 offset:288
    ds_read_b128 v[152:155], v214 offset:352
    ds_read_b128 v[156:159], v214 offset:0
    ds_read_b128 v[160:163], v214 offset:64
    ds_read_b128 v[164:167], v214 offset:128
    ds_read_b128 v[168:171], v214 offset:4320
    ds_read_b128 v[172:175], v214 offset:4384
    ds_read_b128 v[176:179], v214 offset:4448
    ds_read_b128 v[180:183], v214 offset:4096
    ds_read_b128 v[184:187], v214 offset:4160
    ds_read_b128 v[188:191], v214 offset:4224
    v_cvt_pk_bf16_f32 v192, v48, v49
    v_cvt_pk_bf16_f32 v193, v50, v51
    v_cvt_pk_bf16_f32 v194, v52, v53
    v_cvt_pk_bf16_f32 v195, v54, v55
    buffer_store_dwordx4 v[192:195], v205, s[16:19], s35 offen offset:0 sc0 sc1
    v_cvt_pk_bf16_f32 v196, v56, v57
    v_cvt_pk_bf16_f32 v197, v58, v59
    v_cvt_pk_bf16_f32 v198, v60, v61
    v_cvt_pk_bf16_f32 v199, v62, v63
    buffer_store_dwordx4 v[196:199], v205, s[16:19], s35 offen offset:64 sc0 sc1
    v_cvt_pk_bf16_f32 v200, v64, v65
    v_cvt_pk_bf16_f32 v201, v66, v67
    v_cvt_pk_bf16_f32 v202, v68, v69
    v_cvt_pk_bf16_f32 v203, v70, v71
    buffer_store_dwordx4 v[200:203], v205, s[16:19], s35 offen offset:128 sc0 sc1
    s_add_u32 s35, s35, 172032
    s_branch L_done
L_fin1:
    ds_read_b128 v[144:147], v214 offset:224
    ds_read_b128 v[148:151], v214 offset:288
    ds_read_b128 v[152:155], v214 offset:352
    ds_read_b128 v[156:159], v214 offset:0
    ds_read_b128 v[160:163], v214 offset:64
    ds_read_b128 v[164:167], v214 offset:128
    ds_read_b128 v[168:171], v214 offset:4320
    ds_read_b128 v[172:175], v214 offset:4384
    ds_read_b128 v[176:179], v214 offset:4448
    ds_read_b128 v[180:183], v214 offset:4096
    ds_read_b128 v[184:187], v214 offset:4160
    ds_read_b128 v[188:191], v214 offset:4224
    v_cvt_pk_bf16_f32 v192, v72, v73
    v_cvt_pk_bf16_f32 v193, v74, v75
    v_cvt_pk_bf16_f32 v194, v76, v77
    v_cvt_pk_bf16_f32 v195, v78, v79
    buffer_store_dwordx4 v[192:195], v205, s[16:19], s35 offen offset:0 sc0 sc1
    v_cvt_pk_bf16_f32 v196, v80, v81
    v_cvt_pk_bf16_f32 v197, v82, v83
    v_cvt_pk_bf16_f32 v198, v84, v85
    v_cvt_pk_bf16_f32 v199, v86, v87
    buffer_store_dwordx4 v[196:199], v205, s[16:19], s35 offen offset:64 sc0 sc1
    v_cvt_pk_bf16_f32 v200, v88, v89
    v_cvt_pk_bf16_f32 v201, v90, v91
    v_cvt_pk_bf16_f32 v202, v92, v93
    v_cvt_pk_bf16_f32 v203, v94, v95
    buffer_store_dwordx4 v[200:203], v205, s[16:19], s35 offen offset:128 sc0 sc1
    s_add_u32 s35, s35, 172032
L_done:
    s_cmp_eq_u32 s30, 0
    s_waitcnt lgkmcnt(0)
    s_cbranch_scc0 L_mid1
    v_mfma_f32_16x16x32_bf16 v[0:3], a[144:147], v[144:147], v[120:123]
    v_mfma_f32_16x16x32_bf16 v[0:3], a[168:171], v[148:151], v[0:3]
    v_mfma_f32_16x16x32_bf16 v[0:3], a[192:195], v[152:155], v[0:3]
    v_mfma_f32_16x16x32_bf16 v[0:3], a[216:219], v[156:159], v[0:3]
    v_mfma_f32_16x16x32_bf16 v[0:3], a[240:243], v[160:163], v[0:3]
    v_mfma_f32_16x16x32_bf16 v[0:3], v[232:235], v[164:167], v[0:3]
    v_mfma_f32_16x16x32_bf16 v[0:3], a[0:3], v[168:171], v[0:3]
    v_mfma_f32_16x16x32_bf16 v[0:3], a[24:27], v[172:175], v[0:3]
    v_mfma_f32_16x16x32_bf16 v[0:3], a[48:51], v[176:179], v[0:3]
    v_mfma_f32_16x16x32_bf16 v[0:3], a[72:75], v[180:183], v[0:3]
    v_mfma_f32_16x16x32_bf16 v[0:3], a[96:99], v[184:187], v[0:3]
    v_mfma_f32_16x16x32_bf16 v[0:3], a[120:123], v[188:191], v[0:3]
    v_mfma_f32_16x16x32_bf16 v[4:7], a[148:151], v[144:147], v[124:127]
    v_mfma_f32_16x16x32_bf16 v[4:7], a[172:175], v[148:151], v[4:7]
    v_mfma_f32_16x16x32_bf16 v[4:7], a[196:199], v[152:155], v[4:7]
    v_mfma_f32_16x16x32_bf16 v[4:7], a[220:223], v[156:159], v[4:7]
    v_mfma_f32_16x16x32_bf16 v[4:7], a[244:247], v[160:163], v[4:7]
    v_mfma_f32_16x16x32_bf16 v[4:7], v[236:239], v[164:167], v[4:7]
    v_mfma_f32_16x16x32_bf16 v[4:7], a[4:7], v[168:171], v[4:7]
    v_mfma_f32_16x16x32_bf16 v[4:7], a[28:31], v[172:175], v[4:7]
    v_mfma_f32_16x16x32_bf16 v[4:7], a[52:55], v[176:179], v[4:7]
    v_mfma_f32_16x16x32_bf16 v[4:7], a[76:79], v[180:183], v[4:7]
    v_mfma_f32_16x16x32_bf16 v[4:7], a[100:103], v[184:187], v[4:7]
    v_mfma_f32_16x16x32_bf16 v[4:7], a[124:127], v[188:191], v[4:7]
    v_mfma_f32_16x16x32_bf16 v[8:11], a[152:155], v[144:147], v[128:131]
    v_mfma_f32_16x16x32_bf16 v[8:11], a[176:179], v[148:151], v[8:11]
    v_mfma_f32_16x16x32_bf16 v[8:11], a[200:203], v[152:155], v[8:11]
    v_mfma_f32_16x16x32_bf16 v[8:11], a[224:227], v[156:159], v[8:11]
    v_mfma_f32_16x16x32_bf16 v[8:11], a[248:251], v[160:163], v[8:11]
    v_mfma_f32_16x16x32_bf16 v[8:11], v[240:243], v[164:167], v[8:11]
    v_mfma_f32_16x16x32_bf16 v[8:11], a[8:11], v[168:171], v[8:11]
    v_mfma_f32_16x16x32_bf16 v[8:11], a[32:35], v[172:175], v[8:11]
    v_mfma_f32_16x16x32_bf16 v[8:11], a[56:59], v[176:179], v[8:11]
    v_mfma_f32_16x16x32_bf16 v[8:11], a[80:83], v[180:183], v[8:11]
    v_mfma_f32_16x16x32_bf16 v[8:11], a[104:107], v[184:187], v[8:11]
    v_mfma_f32_16x16x32_bf16 v[8:11], a[128:131], v[188:191], v[8:11]
    v_mfma_f32_16x16x32_bf16 v[12:15], a[156:159], v[144:147], v[132:135]
    v_mfma_f32_16x16x32_bf16 v[12:15], a[180:183], v[148:151], v[12:15]
    v_mfma_f32_16x16x32_bf16 v[12:15], a[204:207], v[152:155], v[12:15]
    v_mfma_f32_16x16x32_bf16 v[12:15], a[228:231], v[156:159], v[12:15]
    v_mfma_f32_16x16x32_bf16 v[12:15], a[252:255], v[160:163], v[12:15]
    v_mfma_f32_16x16x32_bf16 v[12:15], v[244:247], v[164:167], v[12:15]
    v_mfma_f32_16x16x32_bf16 v[12:15], a[12:15], v[168:171], v[12:15]
    v_mfma_f32_16x16x32_bf16 v[12:15], a[36:39], v[172:175], v[12:15]
    v_mfma_f32_16x16x32_bf16 v[12:15], a[60:63], v[176:179], v[12:15]
    v_mfma_f32_16x16x32_bf16 v[12:15], a[84:87], v[180:183], v[12:15]
    v_mfma_f32_16x16x32_bf16 v[12:15], a[108:111], v[184:187], v[12:15]
    v_mfma_f32_16x16x32_bf16 v[12:15], a[132:135], v[188:191], v[12:15]
    s_nop 7
    v_cvt_pk_bf16_f32 v192, v0, v1
    v_cvt_pk_bf16_f32 v193, v2, v3
    v_cvt_pk_bf16_f32 v194, v4, v5
    v_cvt_pk_bf16_f32 v195, v6, v7
    buffer_store_dwordx4 v[192:195], v205, s[16:19], s57 offen offset:0 sc0 sc1
    v_cvt_pk_bf16_f32 v196, v8, v9
    v_cvt_pk_bf16_f32 v197, v10, v11
    v_cvt_pk_bf16_f32 v198, v12, v13
    v_cvt_pk_bf16_f32 v199, v14, v15
    buffer_store_dwordx4 v[196:199], v205, s[16:19], s57 offen offset:64 sc0 sc1
    s_branch L_done2
L_mid1:
    v_mfma_f32_16x16x32_bf16 v[0:3], a[160:163], v[144:147], v[136:139]
    v_mfma_f32_16x16x32_bf16 v[0:3], a[184:187], v[148:151], v[0:3]
    v_mfma_f32_16x16x32_bf16 v[0:3], a[208:211], v[152:155], v[0:3]
    v_mfma_f32_16x16x32_bf16 v[0:3], a[232:235], v[156:159], v[0:3]
    v_mfma_f32_16x16x32_bf16 v[0:3], v[224:227], v[160:163], v[0:3]
    v_mfma_f32_16x16x32_bf16 v[0:3], v[248:251], v[164:167], v[0:3]
    v_mfma_f32_16x16x32_bf16 v[0:3], a[16:19], v[168:171], v[0:3]
    v_mfma_f32_16x16x32_bf16 v[0:3], a[40:43], v[172:175], v[0:3]
    v_mfma_f32_16x16x32_bf16 v[0:3], a[64:67], v[176:179], v[0:3]
    v_mfma_f32_16x16x32_bf16 v[0:3], a[88:91], v[180:183], v[0:3]
    v_mfma_f32_16x16x32_bf16 v[0:3], a[112:115], v[184:187], v[0:3]
    v_mfma_f32_16x16x32_bf16 v[0:3], a[136:139], v[188:191], v[0:3]
    v_mfma_f32_16x16x32_bf16 v[4:7], a[164:167], v[144:147], v[140:143]
    v_mfma_f32_16x16x32_bf16 v[4:7], a[188:191], v[148:151], v[4:7]
    v_mfma_f32_16x16x32_bf16 v[4:7], a[212:215], v[152:155], v[4:7]
    v_mfma_f32_16x16x32_bf16 v[4:7], a[236:239], v[156:159], v[4:7]
    v_mfma_f32_16x16x32_bf16 v[4:7], v[228:231], v[160:163], v[4:7]
    v_mfma_f32_16x16x32_bf16 v[4:7], v[252:255], v[164:167], v[4:7]
    v_mfma_f32_16x16x32_bf16 v[4:7], a[20:23], v[168:171], v[4:7]
    v_mfma_f32_16x16x32_bf16 v[4:7], a[44:47], v[172:175], v[4:7]
    v_mfma_f32_16x16x32_bf16 v[4:7], a[68:71], v[176:179], v[4:7]
    v_mfma_f32_16x16x32_bf16 v[4:7], a[92:95], v[180:183], v[4:7]
    v_mfma_f32_16x16x32_bf16 v[4:7], a[116:119], v[184:187], v[4:7]
    v_mfma_f32_16x16x32_bf16 v[4:7], a[140:143], v[188:191], v[4:7]
    s_nop 7
    v_cvt_pk_bf16_f32 v192, v0, v1
    v_cvt_pk_bf16_f32 v193, v2, v3
    v_cvt_pk_bf16_f32 v194, v4, v5
    v_cvt_pk_bf16_f32 v195, v6, v7
    buffer_store_dwordx4 v[192:195], v205, s[16:19], s57 offen offset:128 sc0 sc1
L_done2:
L_end:
    s_endpgm

.section .rodata,"a"
.p2align 6
.amdhsa_kernel standalone__transposed_strided__vision_kernel
  .amdhsa_next_free_vgpr 512
  .amdhsa_next_free_sgpr 102
  .amdhsa_accum_offset 256
  .amdhsa_group_segment_fixed_size 0
  .amdhsa_kernarg_size 48
  .amdhsa_user_sgpr_count 2
  .amdhsa_user_sgpr_kernarg_segment_ptr 1
  .amdhsa_system_sgpr_workgroup_id_x 1
.end_amdhsa_kernel
```
